```python
import torch

def _softmax(x, axis=-1):
    return torch.softmax(x, dim=axis)
def _gelu(x):
    return torch.nn.functional.gelu(x, approximate="tanh")
def _silu(x):
    return torch.nn.functional.silu(x)
def _sigmoid(x):
    return torch.sigmoid(x)
def _layernorm(x, axis=-1, eps=1e-5):
    m = x.mean(dim=axis, keepdim=True)
    v = x.var(dim=axis, keepdim=True, unbiased=False)
    return (x - m) / torch.sqrt(v + eps)
def _scatter_add(tgt, idx, src, axis=0):
    return tgt.clone().index_add_(axis, idx, src)
def _segment_sum(src, seg, n):
    out = torch.zeros((n,) + src.shape[1:], dtype=src.dtype)
    return out.index_add_(0, seg, src)
def _pad(x, pw):
    flat = tuple(v for pair in reversed(pw) for v in pair)
    return torch.nn.functional.pad(x, flat)

kernel_name = 'sequential_preLN__sliding_local_dilated__swiglu_ffn__prompt'

def setup_inputs():

    _w = (lambda a: (lambda t: t.to(torch.bfloat16) if t.is_floating_point() else t)(torch.as_tensor(a)))
    def _A_setup():
        B, S, D = 1, 2048, 448
        return {
            "x": _w((lambda *s: torch.randn(*s, dtype=torch.bfloat16) * 0.05)(B, S, D)),
            "wqkv": _w((lambda *s: torch.randn(*s, dtype=torch.bfloat16) * 0.05)(D, 3 * D)),
            "wo": _w((lambda *s: torch.randn(*s, dtype=torch.bfloat16) * 0.05)(D, D)),
        }
    _A_in = _A_setup()

    def _B_setup():
        B, S, D, F = 1, 2048, 448, 1792
        return {
            "x": _w((lambda *s: torch.randn(*s, dtype=torch.bfloat16) * 0.05)(B, S, D)),
            "w_gate": _w((lambda *s: torch.randn(*s, dtype=torch.bfloat16) * 0.05)(D, F)),
            "w_up": _w((lambda *s: torch.randn(*s, dtype=torch.bfloat16) * 0.05)(D, F)),
            "w_down": _w((lambda *s: torch.randn(*s, dtype=torch.bfloat16) * 0.05)(F, D)),
        }
    _B_in = _B_setup()

    return {
        "A_x": _A_in["x"],
        "A_wqkv": _A_in["wqkv"],
        "A_wo": _A_in["wo"],
        "B_x": _B_in["x"],
        "B_w_gate": _B_in["w_gate"],
        "B_w_up": _B_in["w_up"],
        "B_w_down": _B_in["w_down"],
    }

def reference(A_x, A_wqkv, A_wo, B_x, B_w_gate, B_w_up, B_w_down):
    def _A_ref(x, wqkv, wo):
        B, S, D = x.shape
        H = 16; Dh = D // H
        W, dil = 8, 2
        qkv = (lambda x, *d: x.permute(*d))((x @ wqkv).reshape(B, S, 3, H, Dh), 2, 0, 3, 1, 4)
        q, k, v = qkv[0], qkv[1], qkv[2]
        scale = Dh ** -0.5
        pos = torch.arange(S)
        off = torch.arange(W) * dil
        idx = pos[:, None] - off[None, :]
        mask = idx >= 0
        idx_c = torch.where(mask, idx, 0).reshape(-1)
        kg = k[:, :, idx_c, :].reshape(B, H, S, W, Dh)
        vg = v[:, :, idx_c, :].reshape(B, H, S, W, Dh)
        logits = torch.einsum("bhsd,bhswd->bhsw", q, kg) * scale
        logits = torch.where(mask[None, None, :, :], logits, -1e9)
        attn = _softmax(logits, axis=-1)
        o = torch.einsum("bhsw,bhswd->bhsd", attn, vg)
        return (lambda x, *d: x.permute(*d))(o, 0, 2, 1, 3).reshape(B, S, D) @ wo

    def _B_ref(x, w_gate, w_up, w_down):
        g = _silu(x @ w_gate)
        u = x @ w_up
        return (g * u) @ w_down

    x = A_x
    h = x + _A_ref(_layernorm(x, axis=-1), A_wqkv, A_wo)
    h2 = h + _B_ref(_layernorm(h, axis=-1), B_w_gate, B_w_up, B_w_down)
    return h2
```

```asm
; @launch kernel=k1_qkv_kernel grid=(256,1,1) block=(512,1,1) lds=163840
; @launch kernel=k2_wo_kernel grid=(224,1,1) block=(512,1,1) lds=114688
; @launch kernel=k3_gu_kernel grid=(224,1,1) block=(512,1,1) lds=163840
; @launch kernel=k4_down_kernel grid=(224,1,1) block=(512,1,1) lds=131072
.amdgcn_target "amdgcn-amd-amdhsa--gfx950"
.text
.globl k1_qkv_kernel
.p2align 8
.type k1_qkv_kernel,@function
k1_qkv_kernel:
    s_cmp_ge_u32 s2, 256
    s_cbranch_scc1 k1_qkv_kernel_done
    s_load_dwordx4 s[4:7], s[0:1], 0
    s_load_dwordx4 s[8:11], s[0:1], 16
    s_load_dwordx4 s[12:15], s[0:1], 32
    s_load_dwordx4 s[16:19], s[0:1], 48
    s_load_dwordx2 s[20:21], s[0:1], 72
    s_and_b32 s22, s2, 7
    s_mul_i32 s22, s22, 32
    s_lshr_b32 s23, s2, 3
    s_add_u32 s3, s22, s23
    s_mov_b32 s22, 536870913
    s_mul_hi_u32 s23, s3, s22
    s_mul_i32 s24, s23, 8
    s_sub_u32 s24, s3, s24
    v_and_b32 v1, 63, v0
    v_lshrrev_b32 v2, 6, v0
    v_lshrrev_b32 v7, 5, v1
    v_readfirstlane_b32 s50, v2
    s_waitcnt lgkmcnt(0)
    s_lshl_b32 s51, s50, 10
    s_mov_b32 s28, s4
    s_and_b32 s29, s5, 0xffff
    s_mov_b32 s30, 1835008
    s_mov_b32 s31, 0x00020000
    s_mov_b32 s32, s6
    s_and_b32 s33, s7, 0xffff
    s_mov_b32 s34, 1204224
    s_mov_b32 s35, 0x00020000
    s_add_u32 s40, s20, 6291456
    s_addc_u32 s41, s21, 0
    s_and_b32 s41, s41, 0xffff
    s_mov_b32 s42, 1835008
    s_mov_b32 s43, 0x00020000
    v_add_u32 v12, 1, v2
    v_mul_u32_u24 v3, 43, v12
    v_lshrrev_b32 v3, 7, v3
    v_mul_u32_u24 v4, 3, v3
    v_sub_u32 v4, v12, v4
    s_lshl_b32 s25, s23, 6
    s_sub_i32 s25, s25, 32
    s_mul_i32 s26, s25, 896
    s_mul_i32 s27, s24, 112
    s_cmp_ge_u32 s50, 6
    s_cbranch_scc1 k1_qkv_kernel_xskip
    s_mul_i32 s52, s50, 14336
    v_add_u32 v12, 0, v1
    s_mov_b32 s48, 18725
    v_mul_lo_u32 v13, v12, s48
    v_lshrrev_b32 v13, 20, v13
    v_mul_u32_u24 v14, 56, v13
    v_sub_u32 v14, v12, v14
    v_bfe_u32 v15, v13, 1, 3
    v_xor_b32 v14, v14, v15
    v_lshl_add_u32 v13, v2, 4, v13
    v_mul_u32_u24 v13, 896, v13
    v_lshl_add_u32 v13, v14, 4, v13
    v_add_u32 v13, s26, v13
    s_add_u32 m0, s52, 0
    s_nop 0
    buffer_load_dwordx4 v13, s[28:31], 0 offen lds
    v_add_u32 v12, 64, v1
    s_mov_b32 s48, 18725
    v_mul_lo_u32 v13, v12, s48
    v_lshrrev_b32 v13, 20, v13
    v_mul_u32_u24 v14, 56, v13
    v_sub_u32 v14, v12, v14
    v_bfe_u32 v15, v13, 1, 3
    v_xor_b32 v14, v14, v15
    v_lshl_add_u32 v13, v2, 4, v13
    v_mul_u32_u24 v13, 896, v13
    v_lshl_add_u32 v13, v14, 4, v13
    v_add_u32 v13, s26, v13
    s_add_u32 m0, s52, 1024
    s_nop 0
    buffer_load_dwordx4 v13, s[28:31], 0 offen lds
    v_add_u32 v12, 128, v1
    s_mov_b32 s48, 18725
    v_mul_lo_u32 v13, v12, s48
    v_lshrrev_b32 v13, 20, v13
    v_mul_u32_u24 v14, 56, v13
    v_sub_u32 v14, v12, v14
    v_bfe_u32 v15, v13, 1, 3
    v_xor_b32 v14, v14, v15
    v_lshl_add_u32 v13, v2, 4, v13
    v_mul_u32_u24 v13, 896, v13
    v_lshl_add_u32 v13, v14, 4, v13
    v_add_u32 v13, s26, v13
    s_add_u32 m0, s52, 2048
    s_nop 0
    buffer_load_dwordx4 v13, s[28:31], 0 offen lds
    v_add_u32 v12, 192, v1
    s_mov_b32 s48, 18725
    v_mul_lo_u32 v13, v12, s48
    v_lshrrev_b32 v13, 20, v13
    v_mul_u32_u24 v14, 56, v13
    v_sub_u32 v14, v12, v14
    v_bfe_u32 v15, v13, 1, 3
    v_xor_b32 v14, v14, v15
    v_lshl_add_u32 v13, v2, 4, v13
    v_mul_u32_u24 v13, 896, v13
    v_lshl_add_u32 v13, v14, 4, v13
    v_add_u32 v13, s26, v13
    s_add_u32 m0, s52, 3072
    s_nop 0
    buffer_load_dwordx4 v13, s[28:31], 0 offen lds
    v_add_u32 v12, 256, v1
    s_mov_b32 s48, 18725
    v_mul_lo_u32 v13, v12, s48
    v_lshrrev_b32 v13, 20, v13
    v_mul_u32_u24 v14, 56, v13
    v_sub_u32 v14, v12, v14
    v_bfe_u32 v15, v13, 1, 3
    v_xor_b32 v14, v14, v15
    v_lshl_add_u32 v13, v2, 4, v13
    v_mul_u32_u24 v13, 896, v13
    v_lshl_add_u32 v13, v14, 4, v13
    v_add_u32 v13, s26, v13
    s_add_u32 m0, s52, 4096
    s_nop 0
    buffer_load_dwordx4 v13, s[28:31], 0 offen lds
    v_add_u32 v12, 320, v1
    s_mov_b32 s48, 18725
    v_mul_lo_u32 v13, v12, s48
    v_lshrrev_b32 v13, 20, v13
    v_mul_u32_u24 v14, 56, v13
    v_sub_u32 v14, v12, v14
    v_bfe_u32 v15, v13, 1, 3
    v_xor_b32 v14, v14, v15
    v_lshl_add_u32 v13, v2, 4, v13
    v_mul_u32_u24 v13, 896, v13
    v_lshl_add_u32 v13, v14, 4, v13
    v_add_u32 v13, s26, v13
    s_add_u32 m0, s52, 5120
    s_nop 0
    buffer_load_dwordx4 v13, s[28:31], 0 offen lds
    v_add_u32 v12, 384, v1
    s_mov_b32 s48, 18725
    v_mul_lo_u32 v13, v12, s48
    v_lshrrev_b32 v13, 20, v13
    v_mul_u32_u24 v14, 56, v13
    v_sub_u32 v14, v12, v14
    v_bfe_u32 v15, v13, 1, 3
    v_xor_b32 v14, v14, v15
    v_lshl_add_u32 v13, v2, 4, v13
    v_mul_u32_u24 v13, 896, v13
    v_lshl_add_u32 v13, v14, 4, v13
    v_add_u32 v13, s26, v13
    s_add_u32 m0, s52, 6144
    s_nop 0
    buffer_load_dwordx4 v13, s[28:31], 0 offen lds
    v_add_u32 v12, 448, v1
    s_mov_b32 s48, 18725
    v_mul_lo_u32 v13, v12, s48
    v_lshrrev_b32 v13, 20, v13
    v_mul_u32_u24 v14, 56, v13
    v_sub_u32 v14, v12, v14
    v_bfe_u32 v15, v13, 1, 3
    v_xor_b32 v14, v14, v15
    v_lshl_add_u32 v13, v2, 4, v13
    v_mul_u32_u24 v13, 896, v13
    v_lshl_add_u32 v13, v14, 4, v13
    v_add_u32 v13, s26, v13
    s_add_u32 m0, s52, 7168
    s_nop 0
    buffer_load_dwordx4 v13, s[28:31], 0 offen lds
    v_add_u32 v12, 512, v1
    s_mov_b32 s48, 18725
    v_mul_lo_u32 v13, v12, s48
    v_lshrrev_b32 v13, 20, v13
    v_mul_u32_u24 v14, 56, v13
    v_sub_u32 v14, v12, v14
    v_bfe_u32 v15, v13, 1, 3
    v_xor_b32 v14, v14, v15
    v_lshl_add_u32 v13, v2, 4, v13
    v_mul_u32_u24 v13, 896, v13
    v_lshl_add_u32 v13, v14, 4, v13
    v_add_u32 v13, s26, v13
    s_add_u32 m0, s52, 8192
    s_nop 0
    buffer_load_dwordx4 v13, s[28:31], 0 offen lds
    v_add_u32 v12, 576, v1
    s_mov_b32 s48, 18725
    v_mul_lo_u32 v13, v12, s48
    v_lshrrev_b32 v13, 20, v13
    v_mul_u32_u24 v14, 56, v13
    v_sub_u32 v14, v12, v14
    v_bfe_u32 v15, v13, 1, 3
    v_xor_b32 v14, v14, v15
    v_lshl_add_u32 v13, v2, 4, v13
    v_mul_u32_u24 v13, 896, v13
    v_lshl_add_u32 v13, v14, 4, v13
    v_add_u32 v13, s26, v13
    s_add_u32 m0, s52, 9216
    s_nop 0
    buffer_load_dwordx4 v13, s[28:31], 0 offen lds
    v_add_u32 v12, 640, v1
    s_mov_b32 s48, 18725
    v_mul_lo_u32 v13, v12, s48
    v_lshrrev_b32 v13, 20, v13
    v_mul_u32_u24 v14, 56, v13
    v_sub_u32 v14, v12, v14
    v_bfe_u32 v15, v13, 1, 3
    v_xor_b32 v14, v14, v15
    v_lshl_add_u32 v13, v2, 4, v13
    v_mul_u32_u24 v13, 896, v13
    v_lshl_add_u32 v13, v14, 4, v13
    v_add_u32 v13, s26, v13
    s_add_u32 m0, s52, 10240
    s_nop 0
    buffer_load_dwordx4 v13, s[28:31], 0 offen lds
    v_add_u32 v12, 704, v1
    s_mov_b32 s48, 18725
    v_mul_lo_u32 v13, v12, s48
    v_lshrrev_b32 v13, 20, v13
    v_mul_u32_u24 v14, 56, v13
    v_sub_u32 v14, v12, v14
    v_bfe_u32 v15, v13, 1, 3
    v_xor_b32 v14, v14, v15
    v_lshl_add_u32 v13, v2, 4, v13
    v_mul_u32_u24 v13, 896, v13
    v_lshl_add_u32 v13, v14, 4, v13
    v_add_u32 v13, s26, v13
    s_add_u32 m0, s52, 11264
    s_nop 0
    buffer_load_dwordx4 v13, s[28:31], 0 offen lds
    v_add_u32 v12, 768, v1
    s_mov_b32 s48, 18725
    v_mul_lo_u32 v13, v12, s48
    v_lshrrev_b32 v13, 20, v13
    v_mul_u32_u24 v14, 56, v13
    v_sub_u32 v14, v12, v14
    v_bfe_u32 v15, v13, 1, 3
    v_xor_b32 v14, v14, v15
    v_lshl_add_u32 v13, v2, 4, v13
    v_mul_u32_u24 v13, 896, v13
    v_lshl_add_u32 v13, v14, 4, v13
    v_add_u32 v13, s26, v13
    s_add_u32 m0, s52, 12288
    s_nop 0
    buffer_load_dwordx4 v13, s[28:31], 0 offen lds
    v_add_u32 v12, 832, v1
    s_mov_b32 s48, 18725
    v_mul_lo_u32 v13, v12, s48
    v_lshrrev_b32 v13, 20, v13
    v_mul_u32_u24 v14, 56, v13
    v_sub_u32 v14, v12, v14
    v_bfe_u32 v15, v13, 1, 3
    v_xor_b32 v14, v14, v15
    v_lshl_add_u32 v13, v2, 4, v13
    v_mul_u32_u24 v13, 896, v13
    v_lshl_add_u32 v13, v14, 4, v13
    v_add_u32 v13, s26, v13
    s_add_u32 m0, s52, 13312
    s_nop 0
    buffer_load_dwordx4 v13, s[28:31], 0 offen lds
k1_qkv_kernel_xskip:
    v_lshrrev_b32 v12, 3, v1
    v_lshl_add_u32 v13, v2, 3, v12
    s_mov_b32 s48, 2688
    v_mul_lo_u32 v13, v13, s48
    v_bfe_u32 v14, v1, 2, 1
    v_bfe_u32 v15, v1, 4, 1
    v_xor_b32 v14, v14, v15
    v_lshl_add_u32 v13, v14, 6, v13
    v_and_b32 v14, 3, v1
    v_lshl_add_u32 v162, v14, 4, v13
    v_add_u32 v162, s27, v162
    s_mov_b32 s48, 0
    s_add_u32 m0, s51, 90112
    s_nop 0
    buffer_load_dwordx4 v162, s[32:35], s48 offen lds
    s_mov_b32 s48, 896
    s_add_u32 m0, s51, 98304
    s_nop 0
    buffer_load_dwordx4 v162, s[32:35], s48 offen lds
    s_mov_b32 s48, 1792
    s_add_u32 m0, s51, 106496
    s_nop 0
    buffer_load_dwordx4 v162, s[32:35], s48 offen lds
    s_mov_b32 s48, 172032
    s_add_u32 m0, s51, 114688
    s_nop 0
    buffer_load_dwordx4 v162, s[32:35], s48 offen lds
    s_mov_b32 s48, 172928
    s_add_u32 m0, s51, 122880
    s_nop 0
    buffer_load_dwordx4 v162, s[32:35], s48 offen lds
    s_mov_b32 s48, 173824
    s_add_u32 m0, s51, 131072
    s_nop 0
    buffer_load_dwordx4 v162, s[32:35], s48 offen lds
    s_mov_b32 s48, 344064
    s_add_u32 m0, s51, 139264
    s_nop 0
    buffer_load_dwordx4 v162, s[32:35], s48 offen lds
    s_mov_b32 s48, 344960
    s_add_u32 m0, s51, 147456
    s_nop 0
    buffer_load_dwordx4 v162, s[32:35], s48 offen lds
    s_mov_b32 s48, 345856
    s_add_u32 m0, s51, 155648
    s_nop 0
    buffer_load_dwordx4 v162, s[32:35], s48 offen lds
    v_and_b32 v5, 31, v1
    v_lshl_add_u32 v5, v3, 5, v5
    v_bfe_u32 v8, v1, 2, 2
    v_lshl_add_u32 v9, v7, 3, v8
    v_lshlrev_b32 v9, 7, v9
    v_bfe_u32 v10, v1, 4, 1
    v_lshl_add_u32 v9, v10, 5, v9
    v_and_b32 v10, 3, v1
    v_lshl_add_u32 v9, v10, 3, v9
    v_add_u32 v9, 0, v9
    v_bfe_u32 v8, v1, 3, 1
    v_mul_u32_u24 v11, 8192, v4
    v_add_u32 v9, v9, v11
    v_xor_b32 v10, 0, v8
    v_lshl_add_u32 v154, v10, 6, v9
    v_add_u32 v152, 90112, v154
    v_xor_b32 v10, 1, v8
    v_lshl_add_u32 v155, v10, 6, v9
    v_add_u32 v153, 90112, v155
    v_mul_u32_u24 v9, 896, v5
    v_bfe_u32 v8, v5, 1, 3
    v_add_u32 v10, 0, v7
    v_xor_b32 v10, v10, v8
    v_lshl_add_u32 v158, v10, 4, v9
    v_add_u32 v10, 2, v7
    v_xor_b32 v10, v10, v8
    v_lshl_add_u32 v159, v10, 4, v9
    v_add_u32 v10, 4, v7
    v_xor_b32 v10, v10, v8
    v_lshl_add_u32 v160, v10, 4, v9
    v_add_u32 v10, 6, v7
    v_xor_b32 v10, v10, v8
    v_lshl_add_u32 v161, v10, 4, v9
    v_accvgpr_write_b32 a0, 0
    v_accvgpr_write_b32 a1, 0
    v_accvgpr_write_b32 a2, 0
    v_accvgpr_write_b32 a3, 0
    v_accvgpr_write_b32 a4, 0
    v_accvgpr_write_b32 a5, 0
    v_accvgpr_write_b32 a6, 0
    v_accvgpr_write_b32 a7, 0
    v_accvgpr_write_b32 a8, 0
    v_accvgpr_write_b32 a9, 0
    v_accvgpr_write_b32 a10, 0
    v_accvgpr_write_b32 a11, 0
    v_accvgpr_write_b32 a12, 0
    v_accvgpr_write_b32 a13, 0
    v_accvgpr_write_b32 a14, 0
    v_accvgpr_write_b32 a15, 0
    v_accvgpr_write_b32 a16, 0
    v_accvgpr_write_b32 a17, 0
    v_accvgpr_write_b32 a18, 0
    v_accvgpr_write_b32 a19, 0
    v_accvgpr_write_b32 a20, 0
    v_accvgpr_write_b32 a21, 0
    v_accvgpr_write_b32 a22, 0
    v_accvgpr_write_b32 a23, 0
    v_accvgpr_write_b32 a24, 0
    v_accvgpr_write_b32 a25, 0
    v_accvgpr_write_b32 a26, 0
    v_accvgpr_write_b32 a27, 0
    v_accvgpr_write_b32 a28, 0
    v_accvgpr_write_b32 a29, 0
    v_accvgpr_write_b32 a30, 0
    v_accvgpr_write_b32 a31, 0
    s_waitcnt vmcnt(9)
    s_cmp_ge_u32 s50, 6
    s_cbranch_scc1 k1_qkv_kernel_lnskip
    v_lshrrev_b32 v9, 2, v0
    v_and_b32 v10, 3, v0
    v_bfe_u32 v8, v9, 1, 3
    v_mul_u32_u24 v9, 896, v9
    v_add_u32 v11, 0, v10
    v_xor_b32 v11, v11, v8
    v_lshl_add_u32 v72, v11, 4, v9
    ds_read_b128 v[16:19], v72
    v_add_u32 v11, 4, v10
    v_xor_b32 v11, v11, v8
    v_lshl_add_u32 v73, v11, 4, v9
    ds_read_b128 v[20:23], v73
    v_add_u32 v11, 8, v10
    v_xor_b32 v11, v11, v8
    v_lshl_add_u32 v74, v11, 4, v9
    ds_read_b128 v[24:27], v74
    v_add_u32 v11, 12, v10
    v_xor_b32 v11, v11, v8
    v_lshl_add_u32 v75, v11, 4, v9
    ds_read_b128 v[28:31], v75
    v_add_u32 v11, 16, v10
    v_xor_b32 v11, v11, v8
    v_lshl_add_u32 v76, v11, 4, v9
    ds_read_b128 v[32:35], v76
    v_add_u32 v11, 20, v10
    v_xor_b32 v11, v11, v8
    v_lshl_add_u32 v77, v11, 4, v9
    ds_read_b128 v[36:39], v77
    v_add_u32 v11, 24, v10
    v_xor_b32 v11, v11, v8
    v_lshl_add_u32 v78, v11, 4, v9
    ds_read_b128 v[40:43], v78
    v_add_u32 v11, 28, v10
    v_xor_b32 v11, v11, v8
    v_lshl_add_u32 v79, v11, 4, v9
    ds_read_b128 v[44:47], v79
    v_add_u32 v11, 32, v10
    v_xor_b32 v11, v11, v8
    v_lshl_add_u32 v80, v11, 4, v9
    ds_read_b128 v[48:51], v80
    v_add_u32 v11, 36, v10
    v_xor_b32 v11, v11, v8
    v_lshl_add_u32 v81, v11, 4, v9
    ds_read_b128 v[52:55], v81
    v_add_u32 v11, 40, v10
    v_xor_b32 v11, v11, v8
    v_lshl_add_u32 v82, v11, 4, v9
    ds_read_b128 v[56:59], v82
    v_add_u32 v11, 44, v10
    v_xor_b32 v11, v11, v8
    v_lshl_add_u32 v83, v11, 4, v9
    ds_read_b128 v[60:63], v83
    v_add_u32 v11, 48, v10
    v_xor_b32 v11, v11, v8
    v_lshl_add_u32 v84, v11, 4, v9
    ds_read_b128 v[64:67], v84
    v_add_u32 v11, 52, v10
    v_xor_b32 v11, v11, v8
    v_lshl_add_u32 v85, v11, 4, v9
    ds_read_b128 v[68:71], v85
    s_mov_b32 s26, 0x3f803f80
    v_mov_b32 v12, 0
    v_mov_b32 v13, 0
    v_mov_b32 v14, 0
    v_mov_b32 v15, 0
    s_waitcnt lgkmcnt(13)
    v_dot2_f32_bf16 v12, v16, s26, v12
    v_dot2_f32_bf16 v14, v16, v16, v14
    v_dot2_f32_bf16 v13, v17, s26, v13
    v_dot2_f32_bf16 v15, v17, v17, v15
    v_dot2_f32_bf16 v12, v18, s26, v12
    v_dot2_f32_bf16 v14, v18, v18, v14
    v_dot2_f32_bf16 v13, v19, s26, v13
    v_dot2_f32_bf16 v15, v19, v19, v15
    s_waitcnt lgkmcnt(12)
    v_dot2_f32_bf16 v12, v20, s26, v12
    v_dot2_f32_bf16 v14, v20, v20, v14
    v_dot2_f32_bf16 v13, v21, s26, v13
    v_dot2_f32_bf16 v15, v21, v21, v15
    v_dot2_f32_bf16 v12, v22, s26, v12
    v_dot2_f32_bf16 v14, v22, v22, v14
    v_dot2_f32_bf16 v13, v23, s26, v13
    v_dot2_f32_bf16 v15, v23, v23, v15
    s_waitcnt lgkmcnt(11)
    v_dot2_f32_bf16 v12, v24, s26, v12
    v_dot2_f32_bf16 v14, v24, v24, v14
    v_dot2_f32_bf16 v13, v25, s26, v13
    v_dot2_f32_bf16 v15, v25, v25, v15
    v_dot2_f32_bf16 v12, v26, s26, v12
    v_dot2_f32_bf16 v14, v26, v26, v14
    v_dot2_f32_bf16 v13, v27, s26, v13
    v_dot2_f32_bf16 v15, v27, v27, v15
    s_waitcnt lgkmcnt(10)
    v_dot2_f32_bf16 v12, v28, s26, v12
    v_dot2_f32_bf16 v14, v28, v28, v14
    v_dot2_f32_bf16 v13, v29, s26, v13
    v_dot2_f32_bf16 v15, v29, v29, v15
    v_dot2_f32_bf16 v12, v30, s26, v12
    v_dot2_f32_bf16 v14, v30, v30, v14
    v_dot2_f32_bf16 v13, v31, s26, v13
    v_dot2_f32_bf16 v15, v31, v31, v15
    s_waitcnt lgkmcnt(9)
    v_dot2_f32_bf16 v12, v32, s26, v12
    v_dot2_f32_bf16 v14, v32, v32, v14
    v_dot2_f32_bf16 v13, v33, s26, v13
    v_dot2_f32_bf16 v15, v33, v33, v15
    v_dot2_f32_bf16 v12, v34, s26, v12
    v_dot2_f32_bf16 v14, v34, v34, v14
    v_dot2_f32_bf16 v13, v35, s26, v13
    v_dot2_f32_bf16 v15, v35, v35, v15
    s_waitcnt lgkmcnt(8)
    v_dot2_f32_bf16 v12, v36, s26, v12
    v_dot2_f32_bf16 v14, v36, v36, v14
    v_dot2_f32_bf16 v13, v37, s26, v13
    v_dot2_f32_bf16 v15, v37, v37, v15
    v_dot2_f32_bf16 v12, v38, s26, v12
    v_dot2_f32_bf16 v14, v38, v38, v14
    v_dot2_f32_bf16 v13, v39, s26, v13
    v_dot2_f32_bf16 v15, v39, v39, v15
    s_waitcnt lgkmcnt(7)
    v_dot2_f32_bf16 v12, v40, s26, v12
    v_dot2_f32_bf16 v14, v40, v40, v14
    v_dot2_f32_bf16 v13, v41, s26, v13
    v_dot2_f32_bf16 v15, v41, v41, v15
    v_dot2_f32_bf16 v12, v42, s26, v12
    v_dot2_f32_bf16 v14, v42, v42, v14
    v_dot2_f32_bf16 v13, v43, s26, v13
    v_dot2_f32_bf16 v15, v43, v43, v15
    s_waitcnt lgkmcnt(6)
    v_dot2_f32_bf16 v12, v44, s26, v12
    v_dot2_f32_bf16 v14, v44, v44, v14
    v_dot2_f32_bf16 v13, v45, s26, v13
    v_dot2_f32_bf16 v15, v45, v45, v15
    v_dot2_f32_bf16 v12, v46, s26, v12
    v_dot2_f32_bf16 v14, v46, v46, v14
    v_dot2_f32_bf16 v13, v47, s26, v13
    v_dot2_f32_bf16 v15, v47, v47, v15
    s_waitcnt lgkmcnt(5)
    v_dot2_f32_bf16 v12, v48, s26, v12
    v_dot2_f32_bf16 v14, v48, v48, v14
    v_dot2_f32_bf16 v13, v49, s26, v13
    v_dot2_f32_bf16 v15, v49, v49, v15
    v_dot2_f32_bf16 v12, v50, s26, v12
    v_dot2_f32_bf16 v14, v50, v50, v14
    v_dot2_f32_bf16 v13, v51, s26, v13
    v_dot2_f32_bf16 v15, v51, v51, v15
    s_waitcnt lgkmcnt(4)
    v_dot2_f32_bf16 v12, v52, s26, v12
    v_dot2_f32_bf16 v14, v52, v52, v14
    v_dot2_f32_bf16 v13, v53, s26, v13
    v_dot2_f32_bf16 v15, v53, v53, v15
    v_dot2_f32_bf16 v12, v54, s26, v12
    v_dot2_f32_bf16 v14, v54, v54, v14
    v_dot2_f32_bf16 v13, v55, s26, v13
    v_dot2_f32_bf16 v15, v55, v55, v15
    s_waitcnt lgkmcnt(3)
    v_dot2_f32_bf16 v12, v56, s26, v12
    v_dot2_f32_bf16 v14, v56, v56, v14
    v_dot2_f32_bf16 v13, v57, s26, v13
    v_dot2_f32_bf16 v15, v57, v57, v15
    v_dot2_f32_bf16 v12, v58, s26, v12
    v_dot2_f32_bf16 v14, v58, v58, v14
    v_dot2_f32_bf16 v13, v59, s26, v13
    v_dot2_f32_bf16 v15, v59, v59, v15
    s_waitcnt lgkmcnt(2)
    v_dot2_f32_bf16 v12, v60, s26, v12
    v_dot2_f32_bf16 v14, v60, v60, v14
    v_dot2_f32_bf16 v13, v61, s26, v13
    v_dot2_f32_bf16 v15, v61, v61, v15
    v_dot2_f32_bf16 v12, v62, s26, v12
    v_dot2_f32_bf16 v14, v62, v62, v14
    v_dot2_f32_bf16 v13, v63, s26, v13
    v_dot2_f32_bf16 v15, v63, v63, v15
    s_waitcnt lgkmcnt(1)
    v_dot2_f32_bf16 v12, v64, s26, v12
    v_dot2_f32_bf16 v14, v64, v64, v14
    v_dot2_f32_bf16 v13, v65, s26, v13
    v_dot2_f32_bf16 v15, v65, v65, v15
    v_dot2_f32_bf16 v12, v66, s26, v12
    v_dot2_f32_bf16 v14, v66, v66, v14
    v_dot2_f32_bf16 v13, v67, s26, v13
    v_dot2_f32_bf16 v15, v67, v67, v15
    s_waitcnt lgkmcnt(0)
    v_dot2_f32_bf16 v12, v68, s26, v12
    v_dot2_f32_bf16 v14, v68, v68, v14
    v_dot2_f32_bf16 v13, v69, s26, v13
    v_dot2_f32_bf16 v15, v69, v69, v15
    v_dot2_f32_bf16 v12, v70, s26, v12
    v_dot2_f32_bf16 v14, v70, v70, v14
    v_dot2_f32_bf16 v13, v71, s26, v13
    v_dot2_f32_bf16 v15, v71, v71, v15
    s_nop 3
    v_add_f32 v12, v12, v13
    v_add_f32 v14, v14, v15
    s_nop 1
    v_add_f32_dpp v12, v12, v12 quad_perm:[1,0,3,2] row_mask:0xf bank_mask:0xf
    v_add_f32_dpp v14, v14, v14 quad_perm:[1,0,3,2] row_mask:0xf bank_mask:0xf
    s_nop 1
    v_add_f32_dpp v12, v12, v12 quad_perm:[2,3,0,1] row_mask:0xf bank_mask:0xf
    v_add_f32_dpp v14, v14, v14 quad_perm:[2,3,0,1] row_mask:0xf bank_mask:0xf
    v_mul_f32 v12, 0.002232142857142857, v12
    v_mul_f32 v14, 0.002232142857142857, v14
    v_fma_f32 v14, -v12, v12, v14
    v_max_f32 v14, 0, v14
    v_add_f32 v14, 1e-05, v14
    v_rsq_f32 v15, v14
    s_nop 0
    v_mul_f32 v14, v12, v15
    v_mov_b32 v88, v15
    v_mov_b32 v89, v15
    v_sub_f32 v90, 0, v14
    v_sub_f32 v91, 0, v14
    v_lshlrev_b32 v92, 16, v16
    v_and_b32 v93, 0xffff0000, v16
    v_pk_fma_f32 v[92:93], v[92:93], v[88:89], v[90:91]
    v_cvt_pk_bf16_f32 v16, v92, v93
    v_lshlrev_b32 v94, 16, v17
    v_and_b32 v95, 0xffff0000, v17
    v_pk_fma_f32 v[94:95], v[94:95], v[88:89], v[90:91]
    v_cvt_pk_bf16_f32 v17, v94, v95
    v_lshlrev_b32 v92, 16, v18
    v_and_b32 v93, 0xffff0000, v18
    v_pk_fma_f32 v[92:93], v[92:93], v[88:89], v[90:91]
    v_cvt_pk_bf16_f32 v18, v92, v93
    v_lshlrev_b32 v94, 16, v19
    v_and_b32 v95, 0xffff0000, v19
    v_pk_fma_f32 v[94:95], v[94:95], v[88:89], v[90:91]
    v_cvt_pk_bf16_f32 v19, v94, v95
    ds_write_b128 v72, v[16:19]
    v_lshlrev_b32 v92, 16, v20
    v_and_b32 v93, 0xffff0000, v20
    v_pk_fma_f32 v[92:93], v[92:93], v[88:89], v[90:91]
    v_cvt_pk_bf16_f32 v20, v92, v93
    v_lshlrev_b32 v94, 16, v21
    v_and_b32 v95, 0xffff0000, v21
    v_pk_fma_f32 v[94:95], v[94:95], v[88:89], v[90:91]
    v_cvt_pk_bf16_f32 v21, v94, v95
    v_lshlrev_b32 v92, 16, v22
    v_and_b32 v93, 0xffff0000, v22
    v_pk_fma_f32 v[92:93], v[92:93], v[88:89], v[90:91]
    v_cvt_pk_bf16_f32 v22, v92, v93
    v_lshlrev_b32 v94, 16, v23
    v_and_b32 v95, 0xffff0000, v23
    v_pk_fma_f32 v[94:95], v[94:95], v[88:89], v[90:91]
    v_cvt_pk_bf16_f32 v23, v94, v95
    ds_write_b128 v73, v[20:23]
    v_lshlrev_b32 v92, 16, v24
    v_and_b32 v93, 0xffff0000, v24
    v_pk_fma_f32 v[92:93], v[92:93], v[88:89], v[90:91]
    v_cvt_pk_bf16_f32 v24, v92, v93
    v_lshlrev_b32 v94, 16, v25
    v_and_b32 v95, 0xffff0000, v25
    v_pk_fma_f32 v[94:95], v[94:95], v[88:89], v[90:91]
    v_cvt_pk_bf16_f32 v25, v94, v95
    v_lshlrev_b32 v92, 16, v26
    v_and_b32 v93, 0xffff0000, v26
    v_pk_fma_f32 v[92:93], v[92:93], v[88:89], v[90:91]
    v_cvt_pk_bf16_f32 v26, v92, v93
    v_lshlrev_b32 v94, 16, v27
    v_and_b32 v95, 0xffff0000, v27
    v_pk_fma_f32 v[94:95], v[94:95], v[88:89], v[90:91]
    v_cvt_pk_bf16_f32 v27, v94, v95
    ds_write_b128 v74, v[24:27]
    v_lshlrev_b32 v92, 16, v28
    v_and_b32 v93, 0xffff0000, v28
    v_pk_fma_f32 v[92:93], v[92:93], v[88:89], v[90:91]
    v_cvt_pk_bf16_f32 v28, v92, v93
    v_lshlrev_b32 v94, 16, v29
    v_and_b32 v95, 0xffff0000, v29
    v_pk_fma_f32 v[94:95], v[94:95], v[88:89], v[90:91]
    v_cvt_pk_bf16_f32 v29, v94, v95
    v_lshlrev_b32 v92, 16, v30
    v_and_b32 v93, 0xffff0000, v30
    v_pk_fma_f32 v[92:93], v[92:93], v[88:89], v[90:91]
    v_cvt_pk_bf16_f32 v30, v92, v93
    v_lshlrev_b32 v94, 16, v31
    v_and_b32 v95, 0xffff0000, v31
    v_pk_fma_f32 v[94:95], v[94:95], v[88:89], v[90:91]
    v_cvt_pk_bf16_f32 v31, v94, v95
    ds_write_b128 v75, v[28:31]
    v_lshlrev_b32 v92, 16, v32
    v_and_b32 v93, 0xffff0000, v32
    v_pk_fma_f32 v[92:93], v[92:93], v[88:89], v[90:91]
    v_cvt_pk_bf16_f32 v32, v92, v93
    v_lshlrev_b32 v94, 16, v33
    v_and_b32 v95, 0xffff0000, v33
    v_pk_fma_f32 v[94:95], v[94:95], v[88:89], v[90:91]
    v_cvt_pk_bf16_f32 v33, v94, v95
    v_lshlrev_b32 v92, 16, v34
    v_and_b32 v93, 0xffff0000, v34
    v_pk_fma_f32 v[92:93], v[92:93], v[88:89], v[90:91]
    v_cvt_pk_bf16_f32 v34, v92, v93
    v_lshlrev_b32 v94, 16, v35
    v_and_b32 v95, 0xffff0000, v35
    v_pk_fma_f32 v[94:95], v[94:95], v[88:89], v[90:91]
    v_cvt_pk_bf16_f32 v35, v94, v95
    ds_write_b128 v76, v[32:35]
    v_lshlrev_b32 v92, 16, v36
    v_and_b32 v93, 0xffff0000, v36
    v_pk_fma_f32 v[92:93], v[92:93], v[88:89], v[90:91]
    v_cvt_pk_bf16_f32 v36, v92, v93
    v_lshlrev_b32 v94, 16, v37
    v_and_b32 v95, 0xffff0000, v37
    v_pk_fma_f32 v[94:95], v[94:95], v[88:89], v[90:91]
    v_cvt_pk_bf16_f32 v37, v94, v95
    v_lshlrev_b32 v92, 16, v38
    v_and_b32 v93, 0xffff0000, v38
    v_pk_fma_f32 v[92:93], v[92:93], v[88:89], v[90:91]
    v_cvt_pk_bf16_f32 v38, v92, v93
    v_lshlrev_b32 v94, 16, v39
    v_and_b32 v95, 0xffff0000, v39
    v_pk_fma_f32 v[94:95], v[94:95], v[88:89], v[90:91]
    v_cvt_pk_bf16_f32 v39, v94, v95
    ds_write_b128 v77, v[36:39]
    v_lshlrev_b32 v92, 16, v40
    v_and_b32 v93, 0xffff0000, v40
    v_pk_fma_f32 v[92:93], v[92:93], v[88:89], v[90:91]
    v_cvt_pk_bf16_f32 v40, v92, v93
    v_lshlrev_b32 v94, 16, v41
    v_and_b32 v95, 0xffff0000, v41
    v_pk_fma_f32 v[94:95], v[94:95], v[88:89], v[90:91]
    v_cvt_pk_bf16_f32 v41, v94, v95
    v_lshlrev_b32 v92, 16, v42
    v_and_b32 v93, 0xffff0000, v42
    v_pk_fma_f32 v[92:93], v[92:93], v[88:89], v[90:91]
    v_cvt_pk_bf16_f32 v42, v92, v93
    v_lshlrev_b32 v94, 16, v43
    v_and_b32 v95, 0xffff0000, v43
    v_pk_fma_f32 v[94:95], v[94:95], v[88:89], v[90:91]
    v_cvt_pk_bf16_f32 v43, v94, v95
    ds_write_b128 v78, v[40:43]
    v_lshlrev_b32 v92, 16, v44
    v_and_b32 v93, 0xffff0000, v44
    v_pk_fma_f32 v[92:93], v[92:93], v[88:89], v[90:91]
    v_cvt_pk_bf16_f32 v44, v92, v93
    v_lshlrev_b32 v94, 16, v45
    v_and_b32 v95, 0xffff0000, v45
    v_pk_fma_f32 v[94:95], v[94:95], v[88:89], v[90:91]
    v_cvt_pk_bf16_f32 v45, v94, v95
    v_lshlrev_b32 v92, 16, v46
    v_and_b32 v93, 0xffff0000, v46
    v_pk_fma_f32 v[92:93], v[92:93], v[88:89], v[90:91]
    v_cvt_pk_bf16_f32 v46, v92, v93
    v_lshlrev_b32 v94, 16, v47
    v_and_b32 v95, 0xffff0000, v47
    v_pk_fma_f32 v[94:95], v[94:95], v[88:89], v[90:91]
    v_cvt_pk_bf16_f32 v47, v94, v95
    ds_write_b128 v79, v[44:47]
    v_lshlrev_b32 v92, 16, v48
    v_and_b32 v93, 0xffff0000, v48
    v_pk_fma_f32 v[92:93], v[92:93], v[88:89], v[90:91]
    v_cvt_pk_bf16_f32 v48, v92, v93
    v_lshlrev_b32 v94, 16, v49
    v_and_b32 v95, 0xffff0000, v49
    v_pk_fma_f32 v[94:95], v[94:95], v[88:89], v[90:91]
    v_cvt_pk_bf16_f32 v49, v94, v95
    v_lshlrev_b32 v92, 16, v50
    v_and_b32 v93, 0xffff0000, v50
    v_pk_fma_f32 v[92:93], v[92:93], v[88:89], v[90:91]
    v_cvt_pk_bf16_f32 v50, v92, v93
    v_lshlrev_b32 v94, 16, v51
    v_and_b32 v95, 0xffff0000, v51
    v_pk_fma_f32 v[94:95], v[94:95], v[88:89], v[90:91]
    v_cvt_pk_bf16_f32 v51, v94, v95
    ds_write_b128 v80, v[48:51]
    v_lshlrev_b32 v92, 16, v52
    v_and_b32 v93, 0xffff0000, v52
    v_pk_fma_f32 v[92:93], v[92:93], v[88:89], v[90:91]
    v_cvt_pk_bf16_f32 v52, v92, v93
    v_lshlrev_b32 v94, 16, v53
    v_and_b32 v95, 0xffff0000, v53
    v_pk_fma_f32 v[94:95], v[94:95], v[88:89], v[90:91]
    v_cvt_pk_bf16_f32 v53, v94, v95
    v_lshlrev_b32 v92, 16, v54
    v_and_b32 v93, 0xffff0000, v54
    v_pk_fma_f32 v[92:93], v[92:93], v[88:89], v[90:91]
    v_cvt_pk_bf16_f32 v54, v92, v93
    v_lshlrev_b32 v94, 16, v55
    v_and_b32 v95, 0xffff0000, v55
    v_pk_fma_f32 v[94:95], v[94:95], v[88:89], v[90:91]
    v_cvt_pk_bf16_f32 v55, v94, v95
    ds_write_b128 v81, v[52:55]
    v_lshlrev_b32 v92, 16, v56
    v_and_b32 v93, 0xffff0000, v56
    v_pk_fma_f32 v[92:93], v[92:93], v[88:89], v[90:91]
    v_cvt_pk_bf16_f32 v56, v92, v93
    v_lshlrev_b32 v94, 16, v57
    v_and_b32 v95, 0xffff0000, v57
    v_pk_fma_f32 v[94:95], v[94:95], v[88:89], v[90:91]
    v_cvt_pk_bf16_f32 v57, v94, v95
    v_lshlrev_b32 v92, 16, v58
    v_and_b32 v93, 0xffff0000, v58
    v_pk_fma_f32 v[92:93], v[92:93], v[88:89], v[90:91]
    v_cvt_pk_bf16_f32 v58, v92, v93
    v_lshlrev_b32 v94, 16, v59
    v_and_b32 v95, 0xffff0000, v59
    v_pk_fma_f32 v[94:95], v[94:95], v[88:89], v[90:91]
    v_cvt_pk_bf16_f32 v59, v94, v95
    ds_write_b128 v82, v[56:59]
    v_lshlrev_b32 v92, 16, v60
    v_and_b32 v93, 0xffff0000, v60
    v_pk_fma_f32 v[92:93], v[92:93], v[88:89], v[90:91]
    v_cvt_pk_bf16_f32 v60, v92, v93
    v_lshlrev_b32 v94, 16, v61
    v_and_b32 v95, 0xffff0000, v61
    v_pk_fma_f32 v[94:95], v[94:95], v[88:89], v[90:91]
    v_cvt_pk_bf16_f32 v61, v94, v95
    v_lshlrev_b32 v92, 16, v62
    v_and_b32 v93, 0xffff0000, v62
    v_pk_fma_f32 v[92:93], v[92:93], v[88:89], v[90:91]
    v_cvt_pk_bf16_f32 v62, v92, v93
    v_lshlrev_b32 v94, 16, v63
    v_and_b32 v95, 0xffff0000, v63
    v_pk_fma_f32 v[94:95], v[94:95], v[88:89], v[90:91]
    v_cvt_pk_bf16_f32 v63, v94, v95
    ds_write_b128 v83, v[60:63]
    v_lshlrev_b32 v92, 16, v64
    v_and_b32 v93, 0xffff0000, v64
    v_pk_fma_f32 v[92:93], v[92:93], v[88:89], v[90:91]
    v_cvt_pk_bf16_f32 v64, v92, v93
    v_lshlrev_b32 v94, 16, v65
    v_and_b32 v95, 0xffff0000, v65
    v_pk_fma_f32 v[94:95], v[94:95], v[88:89], v[90:91]
    v_cvt_pk_bf16_f32 v65, v94, v95
    v_lshlrev_b32 v92, 16, v66
    v_and_b32 v93, 0xffff0000, v66
    v_pk_fma_f32 v[92:93], v[92:93], v[88:89], v[90:91]
    v_cvt_pk_bf16_f32 v66, v92, v93
    v_lshlrev_b32 v94, 16, v67
    v_and_b32 v95, 0xffff0000, v67
    v_pk_fma_f32 v[94:95], v[94:95], v[88:89], v[90:91]
    v_cvt_pk_bf16_f32 v67, v94, v95
    ds_write_b128 v84, v[64:67]
    v_lshlrev_b32 v92, 16, v68
    v_and_b32 v93, 0xffff0000, v68
    v_pk_fma_f32 v[92:93], v[92:93], v[88:89], v[90:91]
    v_cvt_pk_bf16_f32 v68, v92, v93
    v_lshlrev_b32 v94, 16, v69
    v_and_b32 v95, 0xffff0000, v69
    v_pk_fma_f32 v[94:95], v[94:95], v[88:89], v[90:91]
    v_cvt_pk_bf16_f32 v69, v94, v95
    v_lshlrev_b32 v92, 16, v70
    v_and_b32 v93, 0xffff0000, v70
    v_pk_fma_f32 v[92:93], v[92:93], v[88:89], v[90:91]
    v_cvt_pk_bf16_f32 v70, v92, v93
    v_lshlrev_b32 v94, 16, v71
    v_and_b32 v95, 0xffff0000, v71
    v_pk_fma_f32 v[94:95], v[94:95], v[88:89], v[90:91]
    v_cvt_pk_bf16_f32 v71, v94, v95
    ds_write_b128 v85, v[68:71]
k1_qkv_kernel_lnskip:
    s_waitcnt lgkmcnt(0)
    s_barrier
    ds_read_b128 v[16:19], v158 offset:0
    ds_read_b128 v[20:23], v159 offset:0
    ds_read_b128 v[24:27], v160 offset:0
    ds_read_b128 v[28:31], v161 offset:0
    ds_read_b128 v[32:35], v158 offset:128
    ds_read_b128 v[36:39], v159 offset:128
    ds_read_b128 v[40:43], v160 offset:128
    ds_read_b128 v[44:47], v161 offset:128
    ds_read_b128 v[48:51], v158 offset:256
    ds_read_b128 v[52:55], v159 offset:256
    ds_read_b128 v[56:59], v160 offset:256
    ds_read_b128 v[60:63], v161 offset:256
    ds_read_b128 v[64:67], v158 offset:384
    ds_read_b128 v[68:71], v159 offset:384
    ds_read_b128 v[72:75], v160 offset:384
    ds_read_b128 v[76:79], v161 offset:384
    ds_read_b128 v[80:83], v158 offset:512
    ds_read_b128 v[84:87], v159 offset:512
    ds_read_b128 v[88:91], v160 offset:512
    ds_read_b128 v[92:95], v161 offset:512
    ds_read_b128 v[96:99], v158 offset:640
    ds_read_b128 v[100:103], v159 offset:640
    ds_read_b128 v[104:107], v160 offset:640
    ds_read_b128 v[108:111], v161 offset:640
    ds_read_b128 v[112:115], v158 offset:768
    ds_read_b128 v[116:119], v159 offset:768
    ds_read_b128 v[120:123], v160 offset:768
    ds_read_b128 v[124:127], v161 offset:768
    s_waitcnt lgkmcnt(0)
    s_waitcnt vmcnt(3)
    s_barrier
    ds_read_b64_tr_b16 v[128:129], v152 offset:0
    ds_read_b64_tr_b16 v[130:131], v152 offset:512
    ds_read_b64_tr_b16 v[132:133], v153 offset:0
    ds_read_b64_tr_b16 v[134:135], v153 offset:512
    ds_read_b64_tr_b16 v[136:137], v152 offset:2048
    ds_read_b64_tr_b16 v[138:139], v152 offset:2560
    ds_read_b64_tr_b16 v[140:141], v153 offset:2048
    ds_read_b64_tr_b16 v[142:143], v153 offset:2560
    ds_read_b64_tr_b16 v[144:145], v152 offset:4096
    ds_read_b64_tr_b16 v[146:147], v152 offset:4608
    s_mov_b32 s48, 516096
    s_add_u32 m0, s51, 0
    s_nop 0
    buffer_load_dwordx4 v162, s[32:35], s48 offen lds
    s_mov_b32 s48, 516992
    s_add_u32 m0, s51, 8192
    s_nop 0
    buffer_load_dwordx4 v162, s[32:35], s48 offen lds
    s_mov_b32 s48, 517888
    s_add_u32 m0, s51, 16384
    s_nop 0
    buffer_load_dwordx4 v162, s[32:35], s48 offen lds
    s_mov_b32 s48, 688128
    s_add_u32 m0, s51, 24576
    s_nop 0
    buffer_load_dwordx4 v162, s[32:35], s48 offen lds
    s_mov_b32 s48, 689024
    s_add_u32 m0, s51, 32768
    s_nop 0
    buffer_load_dwordx4 v162, s[32:35], s48 offen lds
    s_mov_b32 s48, 689920
    s_add_u32 m0, s51, 40960
    s_nop 0
    buffer_load_dwordx4 v162, s[32:35], s48 offen lds
    s_mov_b32 s48, 860160
    s_add_u32 m0, s51, 49152
    s_nop 0
    buffer_load_dwordx4 v162, s[32:35], s48 offen lds
    s_mov_b32 s48, 861056
    s_add_u32 m0, s51, 57344
    s_nop 0
    buffer_load_dwordx4 v162, s[32:35], s48 offen lds
    s_mov_b32 s48, 861952
    s_add_u32 m0, s51, 65536
    s_nop 0
    buffer_load_dwordx4 v162, s[32:35], s48 offen lds
    ds_read_b64_tr_b16 v[148:149], v153 offset:4096
    ds_read_b64_tr_b16 v[150:151], v153 offset:4608
    s_waitcnt lgkmcnt(10)
    v_mfma_f32_32x32x16_bf16 a[0:15], v[128:131], v[16:19], a[0:15]
    ds_read_b64_tr_b16 v[128:129], v152 offset:6144
    ds_read_b64_tr_b16 v[130:131], v152 offset:6656
    s_waitcnt lgkmcnt(10)
    v_mfma_f32_32x32x16_bf16 a[16:31], v[132:135], v[16:19], a[16:31]
    ds_read_b64_tr_b16 v[132:133], v153 offset:6144
    ds_read_b64_tr_b16 v[134:135], v153 offset:6656
    s_waitcnt lgkmcnt(10)
    v_mfma_f32_32x32x16_bf16 a[0:15], v[136:139], v[20:23], a[0:15]
    ds_read_b64_tr_b16 v[136:137], v152 offset:24576
    ds_read_b64_tr_b16 v[138:139], v152 offset:25088
    s_waitcnt lgkmcnt(10)
    v_mfma_f32_32x32x16_bf16 a[16:31], v[140:143], v[20:23], a[16:31]
    ds_read_b64_tr_b16 v[140:141], v153 offset:24576
    ds_read_b64_tr_b16 v[142:143], v153 offset:25088
    s_waitcnt lgkmcnt(10)
    v_mfma_f32_32x32x16_bf16 a[0:15], v[144:147], v[24:27], a[0:15]
    ds_read_b64_tr_b16 v[144:145], v152 offset:26624
    ds_read_b64_tr_b16 v[146:147], v152 offset:27136
    s_waitcnt lgkmcnt(10)
    v_mfma_f32_32x32x16_bf16 a[16:31], v[148:151], v[24:27], a[16:31]
    ds_read_b64_tr_b16 v[148:149], v153 offset:26624
    ds_read_b64_tr_b16 v[150:151], v153 offset:27136
    s_waitcnt lgkmcnt(10)
    v_mfma_f32_32x32x16_bf16 a[0:15], v[128:131], v[28:31], a[0:15]
    ds_read_b64_tr_b16 v[128:129], v152 offset:28672
    ds_read_b64_tr_b16 v[130:131], v152 offset:29184
    s_waitcnt lgkmcnt(10)
    v_mfma_f32_32x32x16_bf16 a[16:31], v[132:135], v[28:31], a[16:31]
    s_waitcnt vmcnt(9)
    s_barrier
    s_mov_b32 s48, 1032192
    s_add_u32 m0, s51, 90112
    s_nop 0
    buffer_load_dwordx4 v162, s[32:35], s48 offen lds
    s_mov_b32 s48, 1033088
    s_add_u32 m0, s51, 98304
    s_nop 0
    buffer_load_dwordx4 v162, s[32:35], s48 offen lds
    s_mov_b32 s48, 1033984
    s_add_u32 m0, s51, 106496
    s_nop 0
    buffer_load_dwordx4 v162, s[32:35], s48 offen lds
    ds_read_b64_tr_b16 v[132:133], v153 offset:28672
    ds_read_b64_tr_b16 v[134:135], v153 offset:29184
    s_waitcnt lgkmcnt(10)
    v_mfma_f32_32x32x16_bf16 a[0:15], v[136:139], v[32:35], a[0:15]
    ds_read_b64_tr_b16 v[136:137], v152 offset:30720
    ds_read_b64_tr_b16 v[138:139], v152 offset:31232
    s_waitcnt lgkmcnt(10)
    v_mfma_f32_32x32x16_bf16 a[16:31], v[140:143], v[32:35], a[16:31]
    ds_read_b64_tr_b16 v[140:141], v153 offset:30720
    ds_read_b64_tr_b16 v[142:143], v153 offset:31232
    s_waitcnt lgkmcnt(10)
    v_mfma_f32_32x32x16_bf16 a[0:15], v[144:147], v[36:39], a[0:15]
    ds_read_b64_tr_b16 v[144:145], v152 offset:49152
    ds_read_b64_tr_b16 v[146:147], v152 offset:49664
    s_waitcnt lgkmcnt(10)
    v_mfma_f32_32x32x16_bf16 a[16:31], v[148:151], v[36:39], a[16:31]
    ds_read_b64_tr_b16 v[148:149], v153 offset:49152
    ds_read_b64_tr_b16 v[150:151], v153 offset:49664
    s_waitcnt lgkmcnt(10)
    v_mfma_f32_32x32x16_bf16 a[0:15], v[128:131], v[40:43], a[0:15]
    ds_read_b64_tr_b16 v[128:129], v152 offset:51200
    ds_read_b64_tr_b16 v[130:131], v152 offset:51712
    s_waitcnt lgkmcnt(10)
    v_mfma_f32_32x32x16_bf16 a[16:31], v[132:135], v[40:43], a[16:31]
    ds_read_b64_tr_b16 v[132:133], v153 offset:51200
    ds_read_b64_tr_b16 v[134:135], v153 offset:51712
    s_waitcnt lgkmcnt(10)
    v_mfma_f32_32x32x16_bf16 a[0:15], v[136:139], v[44:47], a[0:15]
    ds_read_b64_tr_b16 v[136:137], v152 offset:53248
    ds_read_b64_tr_b16 v[138:139], v152 offset:53760
    s_waitcnt lgkmcnt(10)
    v_mfma_f32_32x32x16_bf16 a[16:31], v[140:143], v[44:47], a[16:31]
    s_waitcnt vmcnt(9)
    s_barrier
    ds_read_b64_tr_b16 v[140:141], v153 offset:53248
    ds_read_b64_tr_b16 v[142:143], v153 offset:53760
    s_waitcnt lgkmcnt(10)
    v_mfma_f32_32x32x16_bf16 a[0:15], v[144:147], v[48:51], a[0:15]
    ds_read_b64_tr_b16 v[144:145], v152 offset:55296
    ds_read_b64_tr_b16 v[146:147], v152 offset:55808
    s_waitcnt lgkmcnt(10)
    v_mfma_f32_32x32x16_bf16 a[16:31], v[148:151], v[48:51], a[16:31]
    ds_read_b64_tr_b16 v[148:149], v153 offset:55296
    ds_read_b64_tr_b16 v[150:151], v153 offset:55808
    s_waitcnt lgkmcnt(10)
    v_mfma_f32_32x32x16_bf16 a[0:15], v[128:131], v[52:55], a[0:15]
    ds_read_b64_tr_b16 v[128:129], v154 offset:0
    ds_read_b64_tr_b16 v[130:131], v154 offset:512
    s_waitcnt lgkmcnt(10)
    v_mfma_f32_32x32x16_bf16 a[16:31], v[132:135], v[52:55], a[16:31]
    ds_read_b64_tr_b16 v[132:133], v155 offset:0
    ds_read_b64_tr_b16 v[134:135], v155 offset:512
    s_waitcnt lgkmcnt(10)
    v_mfma_f32_32x32x16_bf16 a[0:15], v[136:139], v[56:59], a[0:15]
    ds_read_b64_tr_b16 v[136:137], v154 offset:2048
    ds_read_b64_tr_b16 v[138:139], v154 offset:2560
    s_waitcnt lgkmcnt(10)
    v_mfma_f32_32x32x16_bf16 a[16:31], v[140:143], v[56:59], a[16:31]
    ds_read_b64_tr_b16 v[140:141], v155 offset:2048
    ds_read_b64_tr_b16 v[142:143], v155 offset:2560
    s_waitcnt lgkmcnt(10)
    v_mfma_f32_32x32x16_bf16 a[0:15], v[144:147], v[60:63], a[0:15]
    ds_read_b64_tr_b16 v[144:145], v154 offset:4096
    ds_read_b64_tr_b16 v[146:147], v154 offset:4608
    s_waitcnt lgkmcnt(10)
    v_mfma_f32_32x32x16_bf16 a[16:31], v[148:151], v[60:63], a[16:31]
    s_waitcnt vmcnt(6)
    s_barrier
    ds_read_b64_tr_b16 v[148:149], v155 offset:4096
    ds_read_b64_tr_b16 v[150:151], v155 offset:4608
    s_waitcnt lgkmcnt(10)
    v_mfma_f32_32x32x16_bf16 a[0:15], v[128:131], v[64:67], a[0:15]
    ds_read_b64_tr_b16 v[128:129], v154 offset:6144
    ds_read_b64_tr_b16 v[130:131], v154 offset:6656
    s_waitcnt lgkmcnt(10)
    v_mfma_f32_32x32x16_bf16 a[16:31], v[132:135], v[64:67], a[16:31]
    ds_read_b64_tr_b16 v[132:133], v155 offset:6144
    ds_read_b64_tr_b16 v[134:135], v155 offset:6656
    s_waitcnt lgkmcnt(10)
    v_mfma_f32_32x32x16_bf16 a[0:15], v[136:139], v[68:71], a[0:15]
    ds_read_b64_tr_b16 v[136:137], v154 offset:24576
    ds_read_b64_tr_b16 v[138:139], v154 offset:25088
    s_waitcnt lgkmcnt(10)
    v_mfma_f32_32x32x16_bf16 a[16:31], v[140:143], v[68:71], a[16:31]
    ds_read_b64_tr_b16 v[140:141], v155 offset:24576
    ds_read_b64_tr_b16 v[142:143], v155 offset:25088
    s_waitcnt lgkmcnt(10)
    v_mfma_f32_32x32x16_bf16 a[0:15], v[144:147], v[72:75], a[0:15]
    ds_read_b64_tr_b16 v[144:145], v154 offset:26624
    ds_read_b64_tr_b16 v[146:147], v154 offset:27136
    s_waitcnt lgkmcnt(10)
    v_mfma_f32_32x32x16_bf16 a[16:31], v[148:151], v[72:75], a[16:31]
    ds_read_b64_tr_b16 v[148:149], v155 offset:26624
    ds_read_b64_tr_b16 v[150:151], v155 offset:27136
    s_waitcnt lgkmcnt(10)
    v_mfma_f32_32x32x16_bf16 a[0:15], v[128:131], v[76:79], a[0:15]
    ds_read_b64_tr_b16 v[128:129], v154 offset:28672
    ds_read_b64_tr_b16 v[130:131], v154 offset:29184
    s_waitcnt lgkmcnt(10)
    v_mfma_f32_32x32x16_bf16 a[16:31], v[132:135], v[76:79], a[16:31]
    s_waitcnt vmcnt(3)
    s_barrier
    ds_read_b64_tr_b16 v[132:133], v155 offset:28672
    ds_read_b64_tr_b16 v[134:135], v155 offset:29184
    s_waitcnt lgkmcnt(10)
    v_mfma_f32_32x32x16_bf16 a[0:15], v[136:139], v[80:83], a[0:15]
    ds_read_b64_tr_b16 v[136:137], v154 offset:30720
    ds_read_b64_tr_b16 v[138:139], v154 offset:31232
    s_waitcnt lgkmcnt(10)
    v_mfma_f32_32x32x16_bf16 a[16:31], v[140:143], v[80:83], a[16:31]
    ds_read_b64_tr_b16 v[140:141], v155 offset:30720
    ds_read_b64_tr_b16 v[142:143], v155 offset:31232
    s_waitcnt lgkmcnt(10)
    v_mfma_f32_32x32x16_bf16 a[0:15], v[144:147], v[84:87], a[0:15]
    ds_read_b64_tr_b16 v[144:145], v154 offset:49152
    ds_read_b64_tr_b16 v[146:147], v154 offset:49664
    s_waitcnt lgkmcnt(10)
    v_mfma_f32_32x32x16_bf16 a[16:31], v[148:151], v[84:87], a[16:31]
    ds_read_b64_tr_b16 v[148:149], v155 offset:49152
    ds_read_b64_tr_b16 v[150:151], v155 offset:49664
    s_waitcnt lgkmcnt(10)
    v_mfma_f32_32x32x16_bf16 a[0:15], v[128:131], v[88:91], a[0:15]
    ds_read_b64_tr_b16 v[128:129], v154 offset:51200
    ds_read_b64_tr_b16 v[130:131], v154 offset:51712
    s_waitcnt lgkmcnt(10)
    v_mfma_f32_32x32x16_bf16 a[16:31], v[132:135], v[88:91], a[16:31]
    ds_read_b64_tr_b16 v[132:133], v155 offset:51200
    ds_read_b64_tr_b16 v[134:135], v155 offset:51712
    s_waitcnt lgkmcnt(10)
    v_mfma_f32_32x32x16_bf16 a[0:15], v[136:139], v[92:95], a[0:15]
    ds_read_b64_tr_b16 v[136:137], v154 offset:53248
    ds_read_b64_tr_b16 v[138:139], v154 offset:53760
    s_waitcnt lgkmcnt(10)
    v_mfma_f32_32x32x16_bf16 a[16:31], v[140:143], v[92:95], a[16:31]
    s_waitcnt vmcnt(0)
    s_barrier
    ds_read_b64_tr_b16 v[140:141], v155 offset:53248
    ds_read_b64_tr_b16 v[142:143], v155 offset:53760
    s_waitcnt lgkmcnt(10)
    v_mfma_f32_32x32x16_bf16 a[0:15], v[144:147], v[96:99], a[0:15]
    ds_read_b64_tr_b16 v[144:145], v154 offset:55296
    ds_read_b64_tr_b16 v[146:147], v154 offset:55808
    s_waitcnt lgkmcnt(10)
    v_mfma_f32_32x32x16_bf16 a[16:31], v[148:151], v[96:99], a[16:31]
    ds_read_b64_tr_b16 v[148:149], v155 offset:55296
    ds_read_b64_tr_b16 v[150:151], v155 offset:55808
    s_waitcnt lgkmcnt(10)
    v_mfma_f32_32x32x16_bf16 a[0:15], v[128:131], v[100:103], a[0:15]
    ds_read_b64_tr_b16 v[128:129], v152 offset:0
    ds_read_b64_tr_b16 v[130:131], v152 offset:512
    s_waitcnt lgkmcnt(10)
    v_mfma_f32_32x32x16_bf16 a[16:31], v[132:135], v[100:103], a[16:31]
    ds_read_b64_tr_b16 v[132:133], v153 offset:0
    ds_read_b64_tr_b16 v[134:135], v153 offset:512
    s_waitcnt lgkmcnt(10)
    v_mfma_f32_32x32x16_bf16 a[0:15], v[136:139], v[104:107], a[0:15]
    ds_read_b64_tr_b16 v[136:137], v152 offset:2048
    ds_read_b64_tr_b16 v[138:139], v152 offset:2560
    s_waitcnt lgkmcnt(10)
    v_mfma_f32_32x32x16_bf16 a[16:31], v[140:143], v[104:107], a[16:31]
    ds_read_b64_tr_b16 v[140:141], v153 offset:2048
    ds_read_b64_tr_b16 v[142:143], v153 offset:2560
    s_waitcnt lgkmcnt(10)
    v_mfma_f32_32x32x16_bf16 a[0:15], v[144:147], v[108:111], a[0:15]
    ds_read_b64_tr_b16 v[144:145], v152 offset:4096
    ds_read_b64_tr_b16 v[146:147], v152 offset:4608
    s_waitcnt lgkmcnt(10)
    v_mfma_f32_32x32x16_bf16 a[16:31], v[148:151], v[108:111], a[16:31]
    s_barrier
    ds_read_b64_tr_b16 v[148:149], v153 offset:4096
    ds_read_b64_tr_b16 v[150:151], v153 offset:4608
    s_waitcnt lgkmcnt(10)
    v_mfma_f32_32x32x16_bf16 a[0:15], v[128:131], v[112:115], a[0:15]
    ds_read_b64_tr_b16 v[128:129], v152 offset:6144
    ds_read_b64_tr_b16 v[130:131], v152 offset:6656
    s_waitcnt lgkmcnt(10)
    v_mfma_f32_32x32x16_bf16 a[16:31], v[132:135], v[112:115], a[16:31]
    ds_read_b64_tr_b16 v[132:133], v153 offset:6144
    ds_read_b64_tr_b16 v[134:135], v153 offset:6656
    s_waitcnt lgkmcnt(10)
    v_mfma_f32_32x32x16_bf16 a[0:15], v[136:139], v[116:119], a[0:15]
    s_waitcnt lgkmcnt(8)
    v_mfma_f32_32x32x16_bf16 a[16:31], v[140:143], v[116:119], a[16:31]
    s_waitcnt lgkmcnt(6)
    v_mfma_f32_32x32x16_bf16 a[0:15], v[144:147], v[120:123], a[0:15]
    s_waitcnt lgkmcnt(4)
    v_mfma_f32_32x32x16_bf16 a[16:31], v[148:151], v[120:123], a[16:31]
    s_waitcnt lgkmcnt(2)
    v_mfma_f32_32x32x16_bf16 a[0:15], v[128:131], v[124:127], a[0:15]
    s_waitcnt lgkmcnt(0)
    v_mfma_f32_32x32x16_bf16 a[16:31], v[132:135], v[124:127], a[16:31]
    s_lshr_b32 s52, s2, 3
    s_and_b32 s53, s2, 7
    s_mov_b32 s56, s8
    s_and_b32 s57, s9, 0xffff
    s_mov_b32 s58, 401408
    s_mov_b32 s59, 0x00020000
    s_mul_i32 s54, s52, 12544
    v_lshlrev_b32 v9, 7, v0
    s_add_u32 s55, s54, 0
    buffer_load_dword v15, v9, s[56:59], s55 offen
    s_nop 15
    s_barrier
    v_mul_u32_u24 v10, 400, v5
    v_lshl_add_u32 v10, v7, 3, v10
    v_lshl_add_u32 v10, v4, 7, v10
    v_accvgpr_read_b32 v166, a0
    v_accvgpr_read_b32 v167, a1
    v_accvgpr_read_b32 v168, a2
    v_accvgpr_read_b32 v169, a3
    v_cvt_pk_bf16_f32 v170, v166, v167
    v_cvt_pk_bf16_f32 v171, v168, v169
    ds_write_b64 v10, v[170:171] offset:0
    v_accvgpr_read_b32 v166, a4
    v_accvgpr_read_b32 v167, a5
    v_accvgpr_read_b32 v168, a6
    v_accvgpr_read_b32 v169, a7
    v_cvt_pk_bf16_f32 v170, v166, v167
    v_cvt_pk_bf16_f32 v171, v168, v169
    ds_write_b64 v10, v[170:171] offset:16
    v_accvgpr_read_b32 v166, a8
    v_accvgpr_read_b32 v167, a9
    v_accvgpr_read_b32 v168, a10
    v_accvgpr_read_b32 v169, a11
    v_cvt_pk_bf16_f32 v170, v166, v167
    v_cvt_pk_bf16_f32 v171, v168, v169
    ds_write_b64 v10, v[170:171] offset:32
    v_accvgpr_read_b32 v166, a12
    v_accvgpr_read_b32 v167, a13
    v_accvgpr_read_b32 v168, a14
    v_accvgpr_read_b32 v169, a15
    v_cvt_pk_bf16_f32 v170, v166, v167
    v_cvt_pk_bf16_f32 v171, v168, v169
    ds_write_b64 v10, v[170:171] offset:48
    v_accvgpr_read_b32 v166, a16
    v_accvgpr_read_b32 v167, a17
    v_accvgpr_read_b32 v168, a18
    v_accvgpr_read_b32 v169, a19
    v_cvt_pk_bf16_f32 v170, v166, v167
    v_cvt_pk_bf16_f32 v171, v168, v169
    ds_write_b64 v10, v[170:171] offset:64
    v_accvgpr_read_b32 v166, a20
    v_accvgpr_read_b32 v167, a21
    v_accvgpr_read_b32 v168, a22
    v_accvgpr_read_b32 v169, a23
    v_cvt_pk_bf16_f32 v170, v166, v167
    v_cvt_pk_bf16_f32 v171, v168, v169
    ds_write_b64 v10, v[170:171] offset:80
    v_accvgpr_read_b32 v166, a24
    v_accvgpr_read_b32 v167, a25
    v_accvgpr_read_b32 v168, a26
    v_accvgpr_read_b32 v169, a27
    v_cvt_pk_bf16_f32 v170, v166, v167
    v_cvt_pk_bf16_f32 v171, v168, v169
    ds_write_b64 v10, v[170:171] offset:96
    v_accvgpr_read_b32 v166, a28
    v_accvgpr_read_b32 v167, a29
    v_accvgpr_read_b32 v168, a30
    v_accvgpr_read_b32 v169, a31
    v_cvt_pk_bf16_f32 v170, v166, v167
    v_cvt_pk_bf16_f32 v171, v168, v169
    ds_write_b64 v10, v[170:171] offset:112
    s_waitcnt lgkmcnt(0)
    s_barrier
    v_lshrrev_b32 v3, 3, v0
    v_bfe_u32 v4, v0, 2, 1
    v_mul_u32_u24 v4, 56, v4
    v_and_b32 v11, 3, v0
    v_add_u32 v5, 32, v3
    v_mul_u32_u24 v5, 400, v5
    v_add_u32 v5, v5, v4
    ds_read_b64 v[16:17], v5 offset:0
    ds_read_b64 v[18:19], v5 offset:8
    ds_read_b64 v[20:21], v5 offset:16
    ds_read_b64 v[22:23], v5 offset:24
    ds_read_b64 v[24:25], v5 offset:32
    ds_read_b64 v[26:27], v5 offset:40
    ds_read_b64 v[28:29], v5 offset:48
    v_mul_u32_u24 v6, 1600, v11
    v_sub_u32 v6, v5, v6
    v_subrev_u32 v6, 800, v6
    ds_read_b64 v[64:65], v6 offset:928
    ds_read_b64 v[66:67], v6 offset:936
    ds_read_b64 v[68:69], v6 offset:944
    ds_read_b64 v[70:71], v6 offset:952
    ds_read_b64 v[72:73], v6 offset:960
    ds_read_b64 v[74:75], v6 offset:968
    ds_read_b64 v[76:77], v6 offset:976
    ds_read_b64 v[78:79], v6 offset:128
    ds_read_b64 v[80:81], v6 offset:136
    ds_read_b64 v[82:83], v6 offset:144
    ds_read_b64 v[84:85], v6 offset:152
    ds_read_b64 v[86:87], v6 offset:160
    ds_read_b64 v[88:89], v6 offset:168
    ds_read_b64 v[90:91], v6 offset:176
    ds_read_b64 v[96:97], v6 offset:1056
    ds_read_b64 v[98:99], v6 offset:1064
    ds_read_b64 v[100:101], v6 offset:1072
    ds_read_b64 v[102:103], v6 offset:1080
    ds_read_b64 v[104:105], v6 offset:1088
    ds_read_b64 v[106:107], v6 offset:1096
    ds_read_b64 v[108:109], v6 offset:1104
    ds_read_b64 v[110:111], v6 offset:256
    ds_read_b64 v[112:113], v6 offset:264
    ds_read_b64 v[114:115], v6 offset:272
    ds_read_b64 v[116:117], v6 offset:280
    ds_read_b64 v[118:119], v6 offset:288
    ds_read_b64 v[120:121], v6 offset:296
    ds_read_b64 v[122:123], v6 offset:304
    s_lshl_b32 s26, s23, 6
    v_add_u32 v3, s26, v3
    v_lshlrev_b32 v12, 2, v11
    v_sub_u32 v12, v3, v12
    v_mov_b32 v48, 0
    v_mov_b32 v49, 0
    s_waitcnt lgkmcnt(14)
    v_dot2_f32_bf16 v48, v64, v16, v48
    v_dot2_f32_bf16 v49, v78, v16, v49
    v_dot2_f32_bf16 v48, v65, v17, v48
    v_dot2_f32_bf16 v49, v79, v17, v49
    v_dot2_f32_bf16 v48, v66, v18, v48
    v_dot2_f32_bf16 v49, v80, v18, v49
    v_dot2_f32_bf16 v48, v67, v19, v48
    v_dot2_f32_bf16 v49, v81, v19, v49
    v_dot2_f32_bf16 v48, v68, v20, v48
    v_dot2_f32_bf16 v49, v82, v20, v49
    v_dot2_f32_bf16 v48, v69, v21, v48
    v_dot2_f32_bf16 v49, v83, v21, v49
    v_dot2_f32_bf16 v48, v70, v22, v48
    v_dot2_f32_bf16 v49, v84, v22, v49
    v_dot2_f32_bf16 v48, v71, v23, v48
    v_dot2_f32_bf16 v49, v85, v23, v49
    v_dot2_f32_bf16 v48, v72, v24, v48
    v_dot2_f32_bf16 v49, v86, v24, v49
    v_dot2_f32_bf16 v48, v73, v25, v48
    v_dot2_f32_bf16 v49, v87, v25, v49
    v_dot2_f32_bf16 v48, v74, v26, v48
    v_dot2_f32_bf16 v49, v88, v26, v49
    v_dot2_f32_bf16 v48, v75, v27, v48
    v_dot2_f32_bf16 v49, v89, v27, v49
    v_dot2_f32_bf16 v48, v76, v28, v48
    v_dot2_f32_bf16 v49, v90, v28, v49
    v_dot2_f32_bf16 v48, v77, v29, v48
    v_dot2_f32_bf16 v49, v91, v29, v49
    v_mov_b32 v8, 0xce6e6b28
    s_nop 2
    v_mul_f32 v48, 0.18898223650461363, v48
    v_cmp_gt_i32 vcc, 0, v12
    s_nop 1
    v_cndmask_b32 v48, v48, v8, vcc
    v_mul_f32 v49, 0.18898223650461363, v49
    v_cmp_gt_i32 vcc, 2, v12
    s_nop 1
    v_cndmask_b32 v49, v49, v8, vcc
    v_max_f32 v56, v48, v49
    s_nop 1
    v_max_f32_dpp v56, v56, v56 quad_perm:[1,0,3,2] row_mask:0xf bank_mask:0xf
    s_nop 1
    v_max_f32_dpp v56, v56, v56 quad_perm:[2,3,0,1] row_mask:0xf bank_mask:0xf
    v_sub_f32 v48, v48, v56
    v_mul_f32 v48, 0x3fb8aa3b, v48
    v_exp_f32 v48, v48
    v_sub_f32 v49, v49, v56
    v_mul_f32 v49, 0x3fb8aa3b, v49
    v_exp_f32 v49, v49
    s_nop 0
    v_add_f32 v57, v48, v49
    s_nop 1
    v_add_f32_dpp v57, v57, v57 quad_perm:[1,0,3,2] row_mask:0xf bank_mask:0xf
    s_nop 1
    v_add_f32_dpp v57, v57, v57 quad_perm:[2,3,0,1] row_mask:0xf bank_mask:0xf
    v_rcp_f32 v57, v57
    s_nop 0
    v_mul_f32 v48, v48, v57
    v_mul_f32 v49, v49, v57
    s_waitcnt lgkmcnt(0)
    v_lshlrev_b32 v8, 16, v96
    v_and_b32 v9, 0xffff0000, v96
    v_mul_f32 v16, v8, v48
    v_mul_f32 v17, v9, v48
    v_lshlrev_b32 v8, 16, v97
    v_and_b32 v9, 0xffff0000, v97
    v_mul_f32 v18, v8, v48
    v_mul_f32 v19, v9, v48
    v_lshlrev_b32 v8, 16, v98
    v_and_b32 v9, 0xffff0000, v98
    v_mul_f32 v20, v8, v48
    v_mul_f32 v21, v9, v48
    v_lshlrev_b32 v8, 16, v99
    v_and_b32 v9, 0xffff0000, v99
    v_mul_f32 v22, v8, v48
    v_mul_f32 v23, v9, v48
    v_lshlrev_b32 v8, 16, v100
    v_and_b32 v9, 0xffff0000, v100
    v_mul_f32 v24, v8, v48
    v_mul_f32 v25, v9, v48
    v_lshlrev_b32 v8, 16, v101
    v_and_b32 v9, 0xffff0000, v101
    v_mul_f32 v26, v8, v48
    v_mul_f32 v27, v9, v48
    v_lshlrev_b32 v8, 16, v102
    v_and_b32 v9, 0xffff0000, v102
    v_mul_f32 v28, v8, v48
    v_mul_f32 v29, v9, v48
    v_lshlrev_b32 v8, 16, v103
    v_and_b32 v9, 0xffff0000, v103
    v_mul_f32 v30, v8, v48
    v_mul_f32 v31, v9, v48
    v_lshlrev_b32 v8, 16, v104
    v_and_b32 v9, 0xffff0000, v104
    v_mul_f32 v32, v8, v48
    v_mul_f32 v33, v9, v48
    v_lshlrev_b32 v8, 16, v105
    v_and_b32 v9, 0xffff0000, v105
    v_mul_f32 v34, v8, v48
    v_mul_f32 v35, v9, v48
    v_lshlrev_b32 v8, 16, v106
    v_and_b32 v9, 0xffff0000, v106
    v_mul_f32 v36, v8, v48
    v_mul_f32 v37, v9, v48
    v_lshlrev_b32 v8, 16, v107
    v_and_b32 v9, 0xffff0000, v107
    v_mul_f32 v38, v8, v48
    v_mul_f32 v39, v9, v48
    v_lshlrev_b32 v8, 16, v108
    v_and_b32 v9, 0xffff0000, v108
    v_mul_f32 v40, v8, v48
    v_mul_f32 v41, v9, v48
    v_lshlrev_b32 v8, 16, v109
    v_and_b32 v9, 0xffff0000, v109
    v_mul_f32 v42, v8, v48
    v_mul_f32 v43, v9, v48
    v_lshlrev_b32 v8, 16, v110
    v_and_b32 v9, 0xffff0000, v110
    v_fmac_f32 v16, v8, v49
    v_fmac_f32 v17, v9, v49
    v_lshlrev_b32 v8, 16, v111
    v_and_b32 v9, 0xffff0000, v111
    v_fmac_f32 v18, v8, v49
    v_fmac_f32 v19, v9, v49
    v_lshlrev_b32 v8, 16, v112
    v_and_b32 v9, 0xffff0000, v112
    v_fmac_f32 v20, v8, v49
    v_fmac_f32 v21, v9, v49
    v_lshlrev_b32 v8, 16, v113
    v_and_b32 v9, 0xffff0000, v113
    v_fmac_f32 v22, v8, v49
    v_fmac_f32 v23, v9, v49
    v_lshlrev_b32 v8, 16, v114
    v_and_b32 v9, 0xffff0000, v114
    v_fmac_f32 v24, v8, v49
    v_fmac_f32 v25, v9, v49
    v_lshlrev_b32 v8, 16, v115
    v_and_b32 v9, 0xffff0000, v115
    v_fmac_f32 v26, v8, v49
    v_fmac_f32 v27, v9, v49
    v_lshlrev_b32 v8, 16, v116
    v_and_b32 v9, 0xffff0000, v116
    v_fmac_f32 v28, v8, v49
    v_fmac_f32 v29, v9, v49
    v_lshlrev_b32 v8, 16, v117
    v_and_b32 v9, 0xffff0000, v117
    v_fmac_f32 v30, v8, v49
    v_fmac_f32 v31, v9, v49
    v_lshlrev_b32 v8, 16, v118
    v_and_b32 v9, 0xffff0000, v118
    v_fmac_f32 v32, v8, v49
    v_fmac_f32 v33, v9, v49
    v_lshlrev_b32 v8, 16, v119
    v_and_b32 v9, 0xffff0000, v119
    v_fmac_f32 v34, v8, v49
    v_fmac_f32 v35, v9, v49
    v_lshlrev_b32 v8, 16, v120
    v_and_b32 v9, 0xffff0000, v120
    v_fmac_f32 v36, v8, v49
    v_fmac_f32 v37, v9, v49
    v_lshlrev_b32 v8, 16, v121
    v_and_b32 v9, 0xffff0000, v121
    v_fmac_f32 v38, v8, v49
    v_fmac_f32 v39, v9, v49
    v_lshlrev_b32 v8, 16, v122
    v_and_b32 v9, 0xffff0000, v122
    v_fmac_f32 v40, v8, v49
    v_fmac_f32 v41, v9, v49
    v_lshlrev_b32 v8, 16, v123
    v_and_b32 v9, 0xffff0000, v123
    v_fmac_f32 v42, v8, v49
    v_fmac_f32 v43, v9, v49
    s_nop 1
    v_add_f32_dpp v16, v16, v16 quad_perm:[1,0,3,2] row_mask:0xf bank_mask:0xf
    v_add_f32_dpp v17, v17, v17 quad_perm:[1,0,3,2] row_mask:0xf bank_mask:0xf
    v_add_f32_dpp v18, v18, v18 quad_perm:[1,0,3,2] row_mask:0xf bank_mask:0xf
    v_add_f32_dpp v19, v19, v19 quad_perm:[1,0,3,2] row_mask:0xf bank_mask:0xf
    v_add_f32_dpp v20, v20, v20 quad_perm:[1,0,3,2] row_mask:0xf bank_mask:0xf
    v_add_f32_dpp v21, v21, v21 quad_perm:[1,0,3,2] row_mask:0xf bank_mask:0xf
    v_add_f32_dpp v22, v22, v22 quad_perm:[1,0,3,2] row_mask:0xf bank_mask:0xf
    v_add_f32_dpp v23, v23, v23 quad_perm:[1,0,3,2] row_mask:0xf bank_mask:0xf
    v_add_f32_dpp v24, v24, v24 quad_perm:[1,0,3,2] row_mask:0xf bank_mask:0xf
    v_add_f32_dpp v25, v25, v25 quad_perm:[1,0,3,2] row_mask:0xf bank_mask:0xf
    v_add_f32_dpp v26, v26, v26 quad_perm:[1,0,3,2] row_mask:0xf bank_mask:0xf
    v_add_f32_dpp v27, v27, v27 quad_perm:[1,0,3,2] row_mask:0xf bank_mask:0xf
    v_add_f32_dpp v28, v28, v28 quad_perm:[1,0,3,2] row_mask:0xf bank_mask:0xf
    v_add_f32_dpp v29, v29, v29 quad_perm:[1,0,3,2] row_mask:0xf bank_mask:0xf
    v_add_f32_dpp v30, v30, v30 quad_perm:[1,0,3,2] row_mask:0xf bank_mask:0xf
    v_add_f32_dpp v31, v31, v31 quad_perm:[1,0,3,2] row_mask:0xf bank_mask:0xf
    v_add_f32_dpp v32, v32, v32 quad_perm:[1,0,3,2] row_mask:0xf bank_mask:0xf
    v_add_f32_dpp v33, v33, v33 quad_perm:[1,0,3,2] row_mask:0xf bank_mask:0xf
    v_add_f32_dpp v34, v34, v34 quad_perm:[1,0,3,2] row_mask:0xf bank_mask:0xf
    v_add_f32_dpp v35, v35, v35 quad_perm:[1,0,3,2] row_mask:0xf bank_mask:0xf
    v_add_f32_dpp v36, v36, v36 quad_perm:[1,0,3,2] row_mask:0xf bank_mask:0xf
    v_add_f32_dpp v37, v37, v37 quad_perm:[1,0,3,2] row_mask:0xf bank_mask:0xf
    v_add_f32_dpp v38, v38, v38 quad_perm:[1,0,3,2] row_mask:0xf bank_mask:0xf
    v_add_f32_dpp v39, v39, v39 quad_perm:[1,0,3,2] row_mask:0xf bank_mask:0xf
    v_add_f32_dpp v40, v40, v40 quad_perm:[1,0,3,2] row_mask:0xf bank_mask:0xf
    v_add_f32_dpp v41, v41, v41 quad_perm:[1,0,3,2] row_mask:0xf bank_mask:0xf
    v_add_f32_dpp v42, v42, v42 quad_perm:[1,0,3,2] row_mask:0xf bank_mask:0xf
    v_add_f32_dpp v43, v43, v43 quad_perm:[1,0,3,2] row_mask:0xf bank_mask:0xf
    s_nop 1
    v_add_f32_dpp v16, v16, v16 quad_perm:[2,3,0,1] row_mask:0xf bank_mask:0xf
    v_add_f32_dpp v17, v17, v17 quad_perm:[2,3,0,1] row_mask:0xf bank_mask:0xf
    v_add_f32_dpp v18, v18, v18 quad_perm:[2,3,0,1] row_mask:0xf bank_mask:0xf
    v_add_f32_dpp v19, v19, v19 quad_perm:[2,3,0,1] row_mask:0xf bank_mask:0xf
    v_add_f32_dpp v20, v20, v20 quad_perm:[2,3,0,1] row_mask:0xf bank_mask:0xf
    v_add_f32_dpp v21, v21, v21 quad_perm:[2,3,0,1] row_mask:0xf bank_mask:0xf
    v_add_f32_dpp v22, v22, v22 quad_perm:[2,3,0,1] row_mask:0xf bank_mask:0xf
    v_add_f32_dpp v23, v23, v23 quad_perm:[2,3,0,1] row_mask:0xf bank_mask:0xf
    v_add_f32_dpp v24, v24, v24 quad_perm:[2,3,0,1] row_mask:0xf bank_mask:0xf
    v_add_f32_dpp v25, v25, v25 quad_perm:[2,3,0,1] row_mask:0xf bank_mask:0xf
    v_add_f32_dpp v26, v26, v26 quad_perm:[2,3,0,1] row_mask:0xf bank_mask:0xf
    v_add_f32_dpp v27, v27, v27 quad_perm:[2,3,0,1] row_mask:0xf bank_mask:0xf
    v_add_f32_dpp v28, v28, v28 quad_perm:[2,3,0,1] row_mask:0xf bank_mask:0xf
    v_add_f32_dpp v29, v29, v29 quad_perm:[2,3,0,1] row_mask:0xf bank_mask:0xf
    v_add_f32_dpp v30, v30, v30 quad_perm:[2,3,0,1] row_mask:0xf bank_mask:0xf
    v_add_f32_dpp v31, v31, v31 quad_perm:[2,3,0,1] row_mask:0xf bank_mask:0xf
    v_add_f32_dpp v32, v32, v32 quad_perm:[2,3,0,1] row_mask:0xf bank_mask:0xf
    v_add_f32_dpp v33, v33, v33 quad_perm:[2,3,0,1] row_mask:0xf bank_mask:0xf
    v_add_f32_dpp v34, v34, v34 quad_perm:[2,3,0,1] row_mask:0xf bank_mask:0xf
    v_add_f32_dpp v35, v35, v35 quad_perm:[2,3,0,1] row_mask:0xf bank_mask:0xf
    v_add_f32_dpp v36, v36, v36 quad_perm:[2,3,0,1] row_mask:0xf bank_mask:0xf
    v_add_f32_dpp v37, v37, v37 quad_perm:[2,3,0,1] row_mask:0xf bank_mask:0xf
    v_add_f32_dpp v38, v38, v38 quad_perm:[2,3,0,1] row_mask:0xf bank_mask:0xf
    v_add_f32_dpp v39, v39, v39 quad_perm:[2,3,0,1] row_mask:0xf bank_mask:0xf
    v_add_f32_dpp v40, v40, v40 quad_perm:[2,3,0,1] row_mask:0xf bank_mask:0xf
    v_add_f32_dpp v41, v41, v41 quad_perm:[2,3,0,1] row_mask:0xf bank_mask:0xf
    v_add_f32_dpp v42, v42, v42 quad_perm:[2,3,0,1] row_mask:0xf bank_mask:0xf
    v_add_f32_dpp v43, v43, v43 quad_perm:[2,3,0,1] row_mask:0xf bank_mask:0xf
    v_cvt_pk_bf16_f32 v64, v16, v17
    v_cvt_pk_bf16_f32 v65, v18, v19
    v_cvt_pk_bf16_f32 v66, v20, v21
    v_cvt_pk_bf16_f32 v67, v22, v23
    v_cvt_pk_bf16_f32 v68, v24, v25
    v_cvt_pk_bf16_f32 v69, v26, v27
    v_cvt_pk_bf16_f32 v70, v28, v29
    v_cvt_pk_bf16_f32 v71, v30, v31
    v_cvt_pk_bf16_f32 v72, v32, v33
    v_cvt_pk_bf16_f32 v73, v34, v35
    v_cvt_pk_bf16_f32 v74, v36, v37
    v_cvt_pk_bf16_f32 v75, v38, v39
    v_cvt_pk_bf16_f32 v76, v40, v41
    v_cvt_pk_bf16_f32 v77, v42, v43
    v_mov_b32 v78, 0
    v_mov_b32 v79, 0
    v_mul_u32_u24 v5, 896, v3
    v_add_u32 v5, v5, v4
    v_add_u32 v5, s27, v5
    v_lshl_add_u32 v5, v11, 4, v5
    v_cmp_eq_u32 vcc, 1, v11
    s_nop 1
    v_cndmask_b32 v64, v64, v68, vcc
    v_cndmask_b32 v65, v65, v69, vcc
    v_cndmask_b32 v66, v66, v70, vcc
    v_cndmask_b32 v67, v67, v71, vcc
    v_cmp_eq_u32 vcc, 2, v11
    s_nop 1
    v_cndmask_b32 v64, v64, v72, vcc
    v_cndmask_b32 v65, v65, v73, vcc
    v_cndmask_b32 v66, v66, v74, vcc
    v_cndmask_b32 v67, v67, v75, vcc
    v_cmp_eq_u32 vcc, 3, v11
    s_nop 1
    v_cndmask_b32 v64, v64, v76, vcc
    v_cndmask_b32 v65, v65, v77, vcc
    v_cndmask_b32 v66, v66, v78, vcc
    v_cndmask_b32 v67, v67, v79, vcc
    buffer_store_dwordx2 v[64:65], v5, s[40:43], 0 offen
    v_cmp_gt_u32 vcc, 3, v11
    s_and_saveexec_b64 s[92:93], vcc
    buffer_store_dwordx2 v[66:67], v5, s[40:43], 0 offen offset:8
    s_mov_b64 exec, s[92:93]
k1_qkv_kernel_done:
    s_endpgm
.section .rodata,"a"
.p2align 6
.amdhsa_kernel k1_qkv_kernel
  .amdhsa_next_free_vgpr 224
  .amdhsa_next_free_sgpr 102
  .amdhsa_accum_offset 192
  .amdhsa_group_segment_fixed_size 0
  .amdhsa_kernarg_size 80
  .amdhsa_user_sgpr_count 2
  .amdhsa_user_sgpr_kernarg_segment_ptr 1
  .amdhsa_system_sgpr_workgroup_id_x 1
.end_amdhsa_kernel
.text
.globl k2_wo_kernel
.p2align 8
.type k2_wo_kernel,@function
k2_wo_kernel:
    s_cmp_ge_u32 s2, 224
    s_cbranch_scc1 k2_wo_kernel_done
    s_load_dwordx4 s[4:7], s[0:1], 0
    s_load_dwordx4 s[8:11], s[0:1], 16
    s_load_dwordx4 s[12:15], s[0:1], 32
    s_load_dwordx4 s[16:19], s[0:1], 48
    s_load_dwordx2 s[20:21], s[0:1], 72
    s_and_b32 s22, s2, 7
    s_mul_i32 s22, s22, 28
    s_lshr_b32 s23, s2, 3
    s_add_u32 s3, s22, s23
    s_mov_b32 s22, 613566757
    s_mul_hi_u32 s23, s3, s22
    s_mul_i32 s24, s23, 7
    s_sub_u32 s24, s3, s24
    v_and_b32 v1, 63, v0
    v_lshrrev_b32 v2, 6, v0
    v_lshrrev_b32 v7, 5, v1
    v_readfirstlane_b32 s50, v2
    s_waitcnt lgkmcnt(0)
    s_lshl_b32 s51, s50, 10
    s_add_u32 s28, s20, 6291456
    s_addc_u32 s29, s21, 0
    s_and_b32 s29, s29, 0xffff
    s_mov_b32 s30, 1835008
    s_mov_b32 s31, 0x00020000
    s_mov_b32 s32, s8
    s_and_b32 s33, s9, 0xffff
    s_mov_b32 s34, 401408
    s_mov_b32 s35, 0x00020000
    s_add_u32 s40, s20, 8388608
    s_addc_u32 s41, s21, 0
    s_and_b32 s41, s41, 0xffff
    s_mov_b32 s42, 1835008
    s_mov_b32 s43, 0x00020000
    s_mov_b32 s44, s4
    s_and_b32 s45, s5, 0xffff
    s_mov_b32 s46, 1835008
    s_mov_b32 s47, 0x00020000
    v_and_b32 v3, 3, v2
    v_lshrrev_b32 v4, 2, v2
    s_lshl_b32 s25, s23, 6
    s_mul_i32 s26, s25, 896
    s_lshl_b32 s27, s24, 7
    v_lshrrev_b32 v12, 3, v1
    v_lshl_add_u32 v12, v2, 3, v12
    s_mov_b32 s48, 896
    v_mul_lo_u32 v12, v12, s48
    v_and_b32 v13, 1, v2
    v_lshlrev_b32 v13, 2, v13
    v_lshrrev_b32 v14, 4, v1
    v_add_u32 v13, v13, v14
    v_and_b32 v14, 7, v1
    v_xor_b32 v13, v13, v14
    v_lshl_add_u32 v47, v13, 4, v12
    v_add_u32 v47, s26, v47
    v_lshrrev_b32 v12, 3, v1
    v_lshl_add_u32 v13, v2, 3, v12
    s_mov_b32 s48, 896
    v_mul_lo_u32 v13, v13, s48
    v_bfe_u32 v14, v1, 2, 1
    v_bfe_u32 v15, v1, 4, 1
    v_xor_b32 v14, v14, v15
    v_lshl_add_u32 v13, v14, 6, v13
    v_and_b32 v14, 3, v1
    v_lshl_add_u32 v46, v14, 4, v13
    v_add_u32 v46, s27, v46
    s_mov_b32 s48, 0
    s_add_u32 m0, s51, 0
    s_nop 0
    buffer_load_dwordx4 v46, s[32:35], s48 offen lds
    s_mov_b32 s48, 0
    s_add_u32 m0, s51, 8192
    s_nop 0
    buffer_load_dwordx4 v47, s[28:31], s48 offen lds
    s_mov_b32 s48, 57344
    s_add_u32 m0, s51, 16384
    s_nop 0
    buffer_load_dwordx4 v46, s[32:35], s48 offen lds
    s_mov_b32 s48, 128
    s_add_u32 m0, s51, 24576
    s_nop 0
    buffer_load_dwordx4 v47, s[28:31], s48 offen lds
    s_mov_b32 s48, 114688
    s_add_u32 m0, s51, 32768
    s_nop 0
    buffer_load_dwordx4 v46, s[32:35], s48 offen lds
    s_mov_b32 s48, 256
    s_add_u32 m0, s51, 40960
    s_nop 0
    buffer_load_dwordx4 v47, s[28:31], s48 offen lds
    s_mov_b32 s48, 172032
    s_add_u32 m0, s51, 49152
    s_nop 0
    buffer_load_dwordx4 v46, s[32:35], s48 offen lds
    s_mov_b32 s48, 384
    s_add_u32 m0, s51, 57344
    s_nop 0
    buffer_load_dwordx4 v47, s[28:31], s48 offen lds
    s_mov_b32 s48, 229376
    s_add_u32 m0, s51, 65536
    s_nop 0
    buffer_load_dwordx4 v46, s[32:35], s48 offen lds
    s_mov_b32 s48, 512
    s_add_u32 m0, s51, 73728
    s_nop 0
    buffer_load_dwordx4 v47, s[28:31], s48 offen lds
    s_mov_b32 s48, 286720
    s_add_u32 m0, s51, 81920
    s_nop 0
    buffer_load_dwordx4 v46, s[32:35], s48 offen lds
    s_mov_b32 s48, 640
    s_add_u32 m0, s51, 90112
    s_nop 0
    buffer_load_dwordx4 v47, s[28:31], s48 offen lds
    v_bfe_u32 v8, v1, 2, 2
    v_lshl_add_u32 v9, v7, 3, v8
    v_lshl_add_u32 v9, v3, 4, v9
    v_lshlrev_b32 v9, 7, v9
    v_bfe_u32 v10, v1, 4, 1
    v_lshl_add_u32 v9, v10, 5, v9
    v_and_b32 v10, 3, v1
    v_lshl_add_u32 v9, v10, 3, v9
    v_add_u32 v9, 0, v9
    v_bfe_u32 v8, v1, 3, 1
    v_xor_b32 v10, 0, v8
    v_lshl_add_u32 v40, v10, 6, v9
    v_add_u32 v42, 65536, v40
    v_xor_b32 v10, 1, v8
    v_lshl_add_u32 v41, v10, 6, v9
    v_add_u32 v43, 65536, v41
    v_and_b32 v5, 31, v1
    v_lshl_add_u32 v5, v4, 5, v5
    v_lshlrev_b32 v9, 7, v5
    v_bfe_u32 v8, v5, 1, 3
    v_lshl_add_u32 v10, v3, 1, v7
    v_xor_b32 v10, v10, v8
    v_lshl_add_u32 v44, v10, 4, v9
    v_add_u32 v44, 8192, v44
    v_add_u32 v45, 65536, v44
    v_accvgpr_write_b32 a0, 0
    v_accvgpr_write_b32 a1, 0
    v_accvgpr_write_b32 a2, 0
    v_accvgpr_write_b32 a3, 0
    v_accvgpr_write_b32 a4, 0
    v_accvgpr_write_b32 a5, 0
    v_accvgpr_write_b32 a6, 0
    v_accvgpr_write_b32 a7, 0
    v_accvgpr_write_b32 a8, 0
    v_accvgpr_write_b32 a9, 0
    v_accvgpr_write_b32 a10, 0
    v_accvgpr_write_b32 a11, 0
    v_accvgpr_write_b32 a12, 0
    v_accvgpr_write_b32 a13, 0
    v_accvgpr_write_b32 a14, 0
    v_accvgpr_write_b32 a15, 0
    v_accvgpr_write_b32 a16, 0
    v_accvgpr_write_b32 a17, 0
    v_accvgpr_write_b32 a18, 0
    v_accvgpr_write_b32 a19, 0
    v_accvgpr_write_b32 a20, 0
    v_accvgpr_write_b32 a21, 0
    v_accvgpr_write_b32 a22, 0
    v_accvgpr_write_b32 a23, 0
    v_accvgpr_write_b32 a24, 0
    v_accvgpr_write_b32 a25, 0
    v_accvgpr_write_b32 a26, 0
    v_accvgpr_write_b32 a27, 0
    v_accvgpr_write_b32 a28, 0
    v_accvgpr_write_b32 a29, 0
    v_accvgpr_write_b32 a30, 0
    v_accvgpr_write_b32 a31, 0
    s_waitcnt vmcnt(6)
    s_barrier
    ds_read_b128 v[16:19], v44 offset:0
    ds_read_b64_tr_b16 v[20:21], v40 offset:0
    ds_read_b64_tr_b16 v[22:23], v40 offset:512
    ds_read_b64_tr_b16 v[24:25], v41 offset:0
    ds_read_b64_tr_b16 v[26:27], v41 offset:512
    s_mov_b32 s48, 344064
    s_add_u32 m0, s51, 98304
    s_nop 0
    buffer_load_dwordx4 v46, s[32:35], s48 offen lds
    s_mov_b32 s48, 768
    s_add_u32 m0, s51, 106496
    s_nop 0
    buffer_load_dwordx4 v47, s[28:31], s48 offen lds
    ds_read_b128 v[28:31], v44 offset:16384
    ds_read_b64_tr_b16 v[32:33], v40 offset:16384
    ds_read_b64_tr_b16 v[34:35], v40 offset:16896
    ds_read_b64_tr_b16 v[36:37], v41 offset:16384
    ds_read_b64_tr_b16 v[38:39], v41 offset:16896
    s_waitcnt lgkmcnt(7)
    v_mfma_f32_32x32x16_bf16 a[0:15], v[20:23], v[16:19], a[0:15]
    s_waitcnt lgkmcnt(5)
    v_mfma_f32_32x32x16_bf16 a[16:31], v[24:27], v[16:19], a[16:31]
    ds_read_b128 v[16:19], v44 offset:32768
    ds_read_b64_tr_b16 v[20:21], v40 offset:32768
    ds_read_b64_tr_b16 v[22:23], v40 offset:33280
    ds_read_b64_tr_b16 v[24:25], v41 offset:32768
    ds_read_b64_tr_b16 v[26:27], v41 offset:33280
    s_waitcnt lgkmcnt(7)
    v_mfma_f32_32x32x16_bf16 a[0:15], v[32:35], v[28:31], a[0:15]
    s_waitcnt lgkmcnt(5)
    v_mfma_f32_32x32x16_bf16 a[16:31], v[36:39], v[28:31], a[16:31]
    s_waitcnt vmcnt(4)
    s_barrier
    ds_read_b128 v[28:31], v44 offset:49152
    ds_read_b64_tr_b16 v[32:33], v40 offset:49152
    ds_read_b64_tr_b16 v[34:35], v40 offset:49664
    ds_read_b64_tr_b16 v[36:37], v41 offset:49152
    ds_read_b64_tr_b16 v[38:39], v41 offset:49664
    s_waitcnt lgkmcnt(7)
    v_mfma_f32_32x32x16_bf16 a[0:15], v[20:23], v[16:19], a[0:15]
    s_waitcnt lgkmcnt(5)
    v_mfma_f32_32x32x16_bf16 a[16:31], v[24:27], v[16:19], a[16:31]
    ds_read_b128 v[16:19], v45 offset:0
    ds_read_b64_tr_b16 v[20:21], v42 offset:0
    ds_read_b64_tr_b16 v[22:23], v42 offset:512
    ds_read_b64_tr_b16 v[24:25], v43 offset:0
    ds_read_b64_tr_b16 v[26:27], v43 offset:512
    s_waitcnt lgkmcnt(7)
    v_mfma_f32_32x32x16_bf16 a[0:15], v[32:35], v[28:31], a[0:15]
    s_waitcnt lgkmcnt(5)
    v_mfma_f32_32x32x16_bf16 a[16:31], v[36:39], v[28:31], a[16:31]
    s_waitcnt vmcnt(0)
    s_barrier
    ds_read_b128 v[28:31], v45 offset:16384
    ds_read_b64_tr_b16 v[32:33], v42 offset:16384
    ds_read_b64_tr_b16 v[34:35], v42 offset:16896
    ds_read_b64_tr_b16 v[36:37], v43 offset:16384
    ds_read_b64_tr_b16 v[38:39], v43 offset:16896
    s_waitcnt lgkmcnt(7)
    v_mfma_f32_32x32x16_bf16 a[0:15], v[20:23], v[16:19], a[0:15]
    s_waitcnt lgkmcnt(5)
    v_mfma_f32_32x32x16_bf16 a[16:31], v[24:27], v[16:19], a[16:31]
    ds_read_b128 v[16:19], v45 offset:32768
    ds_read_b64_tr_b16 v[20:21], v42 offset:32768
    ds_read_b64_tr_b16 v[22:23], v42 offset:33280
    ds_read_b64_tr_b16 v[24:25], v43 offset:32768
    ds_read_b64_tr_b16 v[26:27], v43 offset:33280
    s_waitcnt lgkmcnt(7)
    v_mfma_f32_32x32x16_bf16 a[0:15], v[32:35], v[28:31], a[0:15]
    s_waitcnt lgkmcnt(5)
    v_mfma_f32_32x32x16_bf16 a[16:31], v[36:39], v[28:31], a[16:31]
    s_barrier
    s_waitcnt lgkmcnt(2)
    v_mfma_f32_32x32x16_bf16 a[0:15], v[20:23], v[16:19], a[0:15]
    s_waitcnt lgkmcnt(0)
    v_mfma_f32_32x32x16_bf16 a[16:31], v[24:27], v[16:19], a[16:31]
    s_lshr_b32 s52, s2, 3
    s_and_b32 s53, s2, 7
    s_mov_b32 s56, s12
    s_and_b32 s57, s13, 0xffff
    s_mov_b32 s58, 1605632
    s_mov_b32 s59, 0x00020000
    s_mul_i32 s54, s53, 28
    s_lshr_b32 s54, s54, 4
    s_lshl_b32 s54, s54, 8
    s_mul_i32 s55, s52, 57344
    s_add_u32 s54, s54, s55
    s_mov_b32 s55, 174763
    v_mul_lo_u32 v9, v0, s55
    v_lshrrev_b32 v9, 20, v9
    v_mul_u32_u24 v10, 6, v9
    v_sub_u32 v10, v0, v10
    v_mul_u32_u24 v9, 3584, v9
    v_lshl_add_u32 v9, v10, 7, v9
    v_cmp_gt_u32 vcc, 96, v0
    s_and_saveexec_b64 s[92:93], vcc
    buffer_load_dword v15, v9, s[56:59], s54 offen
    s_mov_b64 exec, s[92:93]
    s_mov_b32 s56, s14
    s_and_b32 s57, s15, 0xffff
    s_mov_b32 s58, 1605632
    s_mov_b32 s59, 0x00020000
    s_mul_i32 s54, s53, 28
    s_lshr_b32 s54, s54, 4
    s_lshl_b32 s54, s54, 8
    s_mul_i32 s55, s52, 57344
    s_add_u32 s54, s54, s55
    s_mov_b32 s55, 174763
    v_mul_lo_u32 v9, v0, s55
    v_lshrrev_b32 v9, 20, v9
    v_mul_u32_u24 v10, 6, v9
    v_sub_u32 v10, v0, v10
    v_mul_u32_u24 v9, 3584, v9
    v_lshl_add_u32 v9, v10, 7, v9
    v_cmp_gt_u32 vcc, 96, v0
    s_and_saveexec_b64 s[92:93], vcc
    buffer_load_dword v15, v9, s[56:59], s54 offen
    s_mov_b64 exec, s[92:93]
    s_nop 15
    s_barrier
    v_mul_u32_u24 v10, 17408, v3
    v_mul_u32_u24 v11, 272, v5
    v_add_u32 v10, v10, v11
    v_lshl_add_u32 v10, v7, 4, v10
    v_accvgpr_read_b32 v100, a0
    v_accvgpr_read_b32 v101, a1
    v_accvgpr_read_b32 v102, a2
    v_accvgpr_read_b32 v103, a3
    ds_write_b128 v10, v[100:103] offset:0
    v_accvgpr_read_b32 v100, a4
    v_accvgpr_read_b32 v101, a5
    v_accvgpr_read_b32 v102, a6
    v_accvgpr_read_b32 v103, a7
    ds_write_b128 v10, v[100:103] offset:32
    v_accvgpr_read_b32 v100, a8
    v_accvgpr_read_b32 v101, a9
    v_accvgpr_read_b32 v102, a10
    v_accvgpr_read_b32 v103, a11
    ds_write_b128 v10, v[100:103] offset:64
    v_accvgpr_read_b32 v100, a12
    v_accvgpr_read_b32 v101, a13
    v_accvgpr_read_b32 v102, a14
    v_accvgpr_read_b32 v103, a15
    ds_write_b128 v10, v[100:103] offset:96
    v_accvgpr_read_b32 v100, a16
    v_accvgpr_read_b32 v101, a17
    v_accvgpr_read_b32 v102, a18
    v_accvgpr_read_b32 v103, a19
    ds_write_b128 v10, v[100:103] offset:128
    v_accvgpr_read_b32 v100, a20
    v_accvgpr_read_b32 v101, a21
    v_accvgpr_read_b32 v102, a22
    v_accvgpr_read_b32 v103, a23
    ds_write_b128 v10, v[100:103] offset:160
    v_accvgpr_read_b32 v100, a24
    v_accvgpr_read_b32 v101, a25
    v_accvgpr_read_b32 v102, a26
    v_accvgpr_read_b32 v103, a27
    ds_write_b128 v10, v[100:103] offset:192
    v_accvgpr_read_b32 v100, a28
    v_accvgpr_read_b32 v101, a29
    v_accvgpr_read_b32 v102, a30
    v_accvgpr_read_b32 v103, a31
    ds_write_b128 v10, v[100:103] offset:224
    v_lshrrev_b32 v11, 3, v1
    v_lshl_add_u32 v11, v2, 3, v11
    v_and_b32 v12, 7, v1
    v_mul_u32_u24 v13, 272, v11
    v_lshl_add_u32 v13, v12, 5, v13
    v_add_u32 v14, s25, v11
    s_mov_b32 s26, 896
    v_mul_lo_u32 v14, v14, s26
    v_lshl_add_u32 v14, v12, 4, v14
    v_add_u32 v14, s27, v14
    buffer_load_dwordx4 v[80:83], v14, s[44:47], 0 offen
    s_waitcnt lgkmcnt(0)
    s_barrier
    ds_read_b128 v[48:51], v13 offset:0
    ds_read_b128 v[52:55], v13 offset:16
    ds_read_b128 v[56:59], v13 offset:17408
    ds_read_b128 v[60:63], v13 offset:17424
    ds_read_b128 v[64:67], v13 offset:34816
    ds_read_b128 v[68:71], v13 offset:34832
    ds_read_b128 v[72:75], v13 offset:52224
    ds_read_b128 v[76:79], v13 offset:52240
    s_waitcnt vmcnt(0) lgkmcnt(0)
    v_add_f32 v48, v48, v56
    v_add_f32 v64, v64, v72
    v_add_f32 v48, v48, v64
    v_add_f32 v49, v49, v57
    v_add_f32 v65, v65, v73
    v_add_f32 v49, v49, v65
    v_add_f32 v50, v50, v58
    v_add_f32 v66, v66, v74
    v_add_f32 v50, v50, v66
    v_add_f32 v51, v51, v59
    v_add_f32 v67, v67, v75
    v_add_f32 v51, v51, v67
    v_add_f32 v52, v52, v60
    v_add_f32 v68, v68, v76
    v_add_f32 v52, v52, v68
    v_add_f32 v53, v53, v61
    v_add_f32 v69, v69, v77
    v_add_f32 v53, v53, v69
    v_add_f32 v54, v54, v62
    v_add_f32 v70, v70, v78
    v_add_f32 v54, v54, v70
    v_add_f32 v55, v55, v63
    v_add_f32 v71, v71, v79
    v_add_f32 v55, v55, v71
    v_lshlrev_b32 v100, 16, v80
    v_and_b32 v101, 0xffff0000, v80
    v_add_f32 v100, v100, v48
    v_add_f32 v101, v101, v49
    v_cvt_pk_bf16_f32 v80, v100, v101
    v_lshlrev_b32 v100, 16, v81
    v_and_b32 v101, 0xffff0000, v81
    v_add_f32 v100, v100, v50
    v_add_f32 v101, v101, v51
    v_cvt_pk_bf16_f32 v81, v100, v101
    v_lshlrev_b32 v100, 16, v82
    v_and_b32 v101, 0xffff0000, v82
    v_add_f32 v100, v100, v52
    v_add_f32 v101, v101, v53
    v_cvt_pk_bf16_f32 v82, v100, v101
    v_lshlrev_b32 v100, 16, v83
    v_and_b32 v101, 0xffff0000, v83
    v_add_f32 v100, v100, v54
    v_add_f32 v101, v101, v55
    v_cvt_pk_bf16_f32 v83, v100, v101
    buffer_store_dwordx4 v[80:83], v14, s[40:43], 0 offen
k2_wo_kernel_done:
    s_endpgm
.section .rodata,"a"
.p2align 6
.amdhsa_kernel k2_wo_kernel
  .amdhsa_next_free_vgpr 160
  .amdhsa_next_free_sgpr 102
  .amdhsa_accum_offset 128
  .amdhsa_group_segment_fixed_size 0
  .amdhsa_kernarg_size 80
  .amdhsa_user_sgpr_count 2
  .amdhsa_user_sgpr_kernarg_segment_ptr 1
  .amdhsa_system_sgpr_workgroup_id_x 1
.end_amdhsa_kernel
.text
.globl k3_gu_kernel
.p2align 8
.type k3_gu_kernel,@function
k3_gu_kernel:
    s_cmp_ge_u32 s2, 224
    s_cbranch_scc1 k3_gu_kernel_done
    s_load_dwordx4 s[4:7], s[0:1], 0
    s_load_dwordx4 s[8:11], s[0:1], 16
    s_load_dwordx4 s[12:15], s[0:1], 32
    s_load_dwordx4 s[16:19], s[0:1], 48
    s_load_dwordx2 s[20:21], s[0:1], 72
    s_and_b32 s22, s2, 7
    s_mul_i32 s22, s22, 28
    s_lshr_b32 s23, s2, 3
    s_add_u32 s3, s22, s23
    s_mov_b32 s22, 268435457
    s_mul_hi_u32 s24, s3, s22
    s_mul_i32 s23, s24, 16
    s_sub_u32 s23, s3, s23
    v_and_b32 v1, 63, v0
    v_lshrrev_b32 v2, 6, v0
    v_lshrrev_b32 v7, 5, v1
    v_readfirstlane_b32 s50, v2
    s_waitcnt lgkmcnt(0)
    s_lshl_b32 s51, s50, 10
    s_add_u32 s28, s20, 8388608
    s_addc_u32 s29, s21, 0
    s_and_b32 s29, s29, 0xffff
    s_mov_b32 s30, 1835008
    s_mov_b32 s31, 0x00020000
    s_mov_b32 s32, s12
    s_and_b32 s33, s13, 0xffff
    s_mov_b32 s34, 1605632
    s_mov_b32 s35, 0x00020000
    s_mov_b32 s36, s14
    s_and_b32 s37, s15, 0xffff
    s_mov_b32 s38, 1605632
    s_mov_b32 s39, 0x00020000
    s_add_u32 s40, s20, 10485760
    s_addc_u32 s41, s21, 0
    s_and_b32 s41, s41, 0xffff
    s_mov_b32 s42, 7340032
    s_mov_b32 s43, 0x00020000
    v_and_b32 v3, 3, v2
    v_lshrrev_b32 v4, 2, v2
    s_lshl_b32 s25, s23, 7
    s_mul_i32 s26, s25, 896
    s_lshl_b32 s27, s24, 8
    s_mul_i32 s52, s50, 14336
    v_add_u32 v12, 0, v1
    s_mov_b32 s48, 18725
    v_mul_lo_u32 v13, v12, s48
    v_lshrrev_b32 v13, 20, v13
    v_mul_u32_u24 v14, 56, v13
    v_sub_u32 v14, v12, v14
    v_bfe_u32 v15, v13, 1, 3
    v_xor_b32 v14, v14, v15
    v_lshl_add_u32 v13, v2, 4, v13
    v_mul_u32_u24 v13, 896, v13
    v_lshl_add_u32 v13, v14, 4, v13
    v_add_u32 v13, s26, v13
    s_add_u32 m0, s52, 0
    s_nop 0
    buffer_load_dwordx4 v13, s[28:31], 0 offen lds
    v_add_u32 v12, 64, v1
    s_mov_b32 s48, 18725
    v_mul_lo_u32 v13, v12, s48
    v_lshrrev_b32 v13, 20, v13
    v_mul_u32_u24 v14, 56, v13
    v_sub_u32 v14, v12, v14
    v_bfe_u32 v15, v13, 1, 3
    v_xor_b32 v14, v14, v15
    v_lshl_add_u32 v13, v2, 4, v13
    v_mul_u32_u24 v13, 896, v13
    v_lshl_add_u32 v13, v14, 4, v13
    v_add_u32 v13, s26, v13
    s_add_u32 m0, s52, 1024
    s_nop 0
    buffer_load_dwordx4 v13, s[28:31], 0 offen lds
    v_add_u32 v12, 128, v1
    s_mov_b32 s48, 18725
    v_mul_lo_u32 v13, v12, s48
    v_lshrrev_b32 v13, 20, v13
    v_mul_u32_u24 v14, 56, v13
    v_sub_u32 v14, v12, v14
    v_bfe_u32 v15, v13, 1, 3
    v_xor_b32 v14, v14, v15
    v_lshl_add_u32 v13, v2, 4, v13
    v_mul_u32_u24 v13, 896, v13
    v_lshl_add_u32 v13, v14, 4, v13
    v_add_u32 v13, s26, v13
    s_add_u32 m0, s52, 2048
    s_nop 0
    buffer_load_dwordx4 v13, s[28:31], 0 offen lds
    v_add_u32 v12, 192, v1
    s_mov_b32 s48, 18725
    v_mul_lo_u32 v13, v12, s48
    v_lshrrev_b32 v13, 20, v13
    v_mul_u32_u24 v14, 56, v13
    v_sub_u32 v14, v12, v14
    v_bfe_u32 v15, v13, 1, 3
    v_xor_b32 v14, v14, v15
    v_lshl_add_u32 v13, v2, 4, v13
    v_mul_u32_u24 v13, 896, v13
    v_lshl_add_u32 v13, v14, 4, v13
    v_add_u32 v13, s26, v13
    s_add_u32 m0, s52, 3072
    s_nop 0
    buffer_load_dwordx4 v13, s[28:31], 0 offen lds
    v_add_u32 v12, 256, v1
    s_mov_b32 s48, 18725
    v_mul_lo_u32 v13, v12, s48
    v_lshrrev_b32 v13, 20, v13
    v_mul_u32_u24 v14, 56, v13
    v_sub_u32 v14, v12, v14
    v_bfe_u32 v15, v13, 1, 3
    v_xor_b32 v14, v14, v15
    v_lshl_add_u32 v13, v2, 4, v13
    v_mul_u32_u24 v13, 896, v13
    v_lshl_add_u32 v13, v14, 4, v13
    v_add_u32 v13, s26, v13
    s_add_u32 m0, s52, 4096
    s_nop 0
    buffer_load_dwordx4 v13, s[28:31], 0 offen lds
    v_add_u32 v12, 320, v1
    s_mov_b32 s48, 18725
    v_mul_lo_u32 v13, v12, s48
    v_lshrrev_b32 v13, 20, v13
    v_mul_u32_u24 v14, 56, v13
    v_sub_u32 v14, v12, v14
    v_bfe_u32 v15, v13, 1, 3
    v_xor_b32 v14, v14, v15
    v_lshl_add_u32 v13, v2, 4, v13
    v_mul_u32_u24 v13, 896, v13
    v_lshl_add_u32 v13, v14, 4, v13
    v_add_u32 v13, s26, v13
    s_add_u32 m0, s52, 5120
    s_nop 0
    buffer_load_dwordx4 v13, s[28:31], 0 offen lds
    v_add_u32 v12, 384, v1
    s_mov_b32 s48, 18725
    v_mul_lo_u32 v13, v12, s48
    v_lshrrev_b32 v13, 20, v13
    v_mul_u32_u24 v14, 56, v13
    v_sub_u32 v14, v12, v14
    v_bfe_u32 v15, v13, 1, 3
    v_xor_b32 v14, v14, v15
    v_lshl_add_u32 v13, v2, 4, v13
    v_mul_u32_u24 v13, 896, v13
    v_lshl_add_u32 v13, v14, 4, v13
    v_add_u32 v13, s26, v13
    s_add_u32 m0, s52, 6144
    s_nop 0
    buffer_load_dwordx4 v13, s[28:31], 0 offen lds
    v_add_u32 v12, 448, v1
    s_mov_b32 s48, 18725
    v_mul_lo_u32 v13, v12, s48
    v_lshrrev_b32 v13, 20, v13
    v_mul_u32_u24 v14, 56, v13
    v_sub_u32 v14, v12, v14
    v_bfe_u32 v15, v13, 1, 3
    v_xor_b32 v14, v14, v15
    v_lshl_add_u32 v13, v2, 4, v13
    v_mul_u32_u24 v13, 896, v13
    v_lshl_add_u32 v13, v14, 4, v13
    v_add_u32 v13, s26, v13
    s_add_u32 m0, s52, 7168
    s_nop 0
    buffer_load_dwordx4 v13, s[28:31], 0 offen lds
    v_add_u32 v12, 512, v1
    s_mov_b32 s48, 18725
    v_mul_lo_u32 v13, v12, s48
    v_lshrrev_b32 v13, 20, v13
    v_mul_u32_u24 v14, 56, v13
    v_sub_u32 v14, v12, v14
    v_bfe_u32 v15, v13, 1, 3
    v_xor_b32 v14, v14, v15
    v_lshl_add_u32 v13, v2, 4, v13
    v_mul_u32_u24 v13, 896, v13
    v_lshl_add_u32 v13, v14, 4, v13
    v_add_u32 v13, s26, v13
    s_add_u32 m0, s52, 8192
    s_nop 0
    buffer_load_dwordx4 v13, s[28:31], 0 offen lds
    v_add_u32 v12, 576, v1
    s_mov_b32 s48, 18725
    v_mul_lo_u32 v13, v12, s48
    v_lshrrev_b32 v13, 20, v13
    v_mul_u32_u24 v14, 56, v13
    v_sub_u32 v14, v12, v14
    v_bfe_u32 v15, v13, 1, 3
    v_xor_b32 v14, v14, v15
    v_lshl_add_u32 v13, v2, 4, v13
    v_mul_u32_u24 v13, 896, v13
    v_lshl_add_u32 v13, v14, 4, v13
    v_add_u32 v13, s26, v13
    s_add_u32 m0, s52, 9216
    s_nop 0
    buffer_load_dwordx4 v13, s[28:31], 0 offen lds
    v_add_u32 v12, 640, v1
    s_mov_b32 s48, 18725
    v_mul_lo_u32 v13, v12, s48
    v_lshrrev_b32 v13, 20, v13
    v_mul_u32_u24 v14, 56, v13
    v_sub_u32 v14, v12, v14
    v_bfe_u32 v15, v13, 1, 3
    v_xor_b32 v14, v14, v15
    v_lshl_add_u32 v13, v2, 4, v13
    v_mul_u32_u24 v13, 896, v13
    v_lshl_add_u32 v13, v14, 4, v13
    v_add_u32 v13, s26, v13
    s_add_u32 m0, s52, 10240
    s_nop 0
    buffer_load_dwordx4 v13, s[28:31], 0 offen lds
    v_add_u32 v12, 704, v1
    s_mov_b32 s48, 18725
    v_mul_lo_u32 v13, v12, s48
    v_lshrrev_b32 v13, 20, v13
    v_mul_u32_u24 v14, 56, v13
    v_sub_u32 v14, v12, v14
    v_bfe_u32 v15, v13, 1, 3
    v_xor_b32 v14, v14, v15
    v_lshl_add_u32 v13, v2, 4, v13
    v_mul_u32_u24 v13, 896, v13
    v_lshl_add_u32 v13, v14, 4, v13
    v_add_u32 v13, s26, v13
    s_add_u32 m0, s52, 11264
    s_nop 0
    buffer_load_dwordx4 v13, s[28:31], 0 offen lds
    v_add_u32 v12, 768, v1
    s_mov_b32 s48, 18725
    v_mul_lo_u32 v13, v12, s48
    v_lshrrev_b32 v13, 20, v13
    v_mul_u32_u24 v14, 56, v13
    v_sub_u32 v14, v12, v14
    v_bfe_u32 v15, v13, 1, 3
    v_xor_b32 v14, v14, v15
    v_lshl_add_u32 v13, v2, 4, v13
    v_mul_u32_u24 v13, 896, v13
    v_lshl_add_u32 v13, v14, 4, v13
    v_add_u32 v13, s26, v13
    s_add_u32 m0, s52, 12288
    s_nop 0
    buffer_load_dwordx4 v13, s[28:31], 0 offen lds
    v_add_u32 v12, 832, v1
    s_mov_b32 s48, 18725
    v_mul_lo_u32 v13, v12, s48
    v_lshrrev_b32 v13, 20, v13
    v_mul_u32_u24 v14, 56, v13
    v_sub_u32 v14, v12, v14
    v_bfe_u32 v15, v13, 1, 3
    v_xor_b32 v14, v14, v15
    v_lshl_add_u32 v13, v2, 4, v13
    v_mul_u32_u24 v13, 896, v13
    v_lshl_add_u32 v13, v14, 4, v13
    v_add_u32 v13, s26, v13
    s_add_u32 m0, s52, 13312
    s_nop 0
    buffer_load_dwordx4 v13, s[28:31], 0 offen lds
    v_lshrrev_b32 v12, 4, v1
    v_lshl_add_u32 v13, v2, 2, v12
    s_mov_b32 s48, 3584
    v_mul_lo_u32 v13, v13, s48
    v_bfe_u32 v14, v1, 2, 2
    v_xor_b32 v14, v14, v12
    v_lshl_add_u32 v13, v14, 6, v13
    v_and_b32 v14, 3, v1
    v_lshl_add_u32 v162, v14, 4, v13
    v_add_u32 v162, s27, v162
    s_mov_b32 s48, 0
    s_add_u32 m0, s51, 114688
    s_nop 0
    buffer_load_dwordx4 v162, s[32:35], s48 offen lds
    s_mov_b32 s48, 0
    s_add_u32 m0, s51, 122880
    s_nop 0
    buffer_load_dwordx4 v162, s[36:39], s48 offen lds
    s_mov_b32 s48, 114688
    s_add_u32 m0, s51, 131072
    s_nop 0
    buffer_load_dwordx4 v162, s[32:35], s48 offen lds
    s_mov_b32 s48, 114688
    s_add_u32 m0, s51, 139264
    s_nop 0
    buffer_load_dwordx4 v162, s[36:39], s48 offen lds
    s_mov_b32 s48, 229376
    s_add_u32 m0, s51, 147456
    s_nop 0
    buffer_load_dwordx4 v162, s[32:35], s48 offen lds
    s_mov_b32 s48, 229376
    s_add_u32 m0, s51, 155648
    s_nop 0
    buffer_load_dwordx4 v162, s[36:39], s48 offen lds
    v_and_b32 v5, 31, v1
    v_lshl_add_u32 v5, v3, 5, v5
    v_bfe_u32 v8, v1, 2, 2
    v_lshl_add_u32 v9, v7, 3, v8
    v_lshlrev_b32 v9, 8, v9
    v_bfe_u32 v10, v1, 4, 1
    v_lshl_add_u32 v9, v10, 5, v9
    v_and_b32 v10, 3, v1
    v_lshl_add_u32 v9, v10, 3, v9
    v_add_u32 v9, 0, v9
    v_lshl_add_u32 v10, v4, 1, 0
    v_xor_b32 v10, v10, v8
    v_lshl_add_u32 v154, v10, 6, v9
    v_add_u32 v152, 114688, v154
    v_add_u32 v156, 65536, v154
    v_lshl_add_u32 v10, v4, 1, 1
    v_xor_b32 v10, v10, v8
    v_lshl_add_u32 v155, v10, 6, v9
    v_add_u32 v153, 114688, v155
    v_add_u32 v157, 65536, v155
    v_mul_u32_u24 v9, 896, v5
    v_bfe_u32 v8, v5, 1, 3
    v_add_u32 v10, 0, v7
    v_xor_b32 v10, v10, v8
    v_lshl_add_u32 v158, v10, 4, v9
    v_add_u32 v10, 2, v7
    v_xor_b32 v10, v10, v8
    v_lshl_add_u32 v159, v10, 4, v9
    v_add_u32 v10, 4, v7
    v_xor_b32 v10, v10, v8
    v_lshl_add_u32 v160, v10, 4, v9
    v_add_u32 v10, 6, v7
    v_xor_b32 v10, v10, v8
    v_lshl_add_u32 v161, v10, 4, v9
    v_accvgpr_write_b32 a0, 0
    v_accvgpr_write_b32 a1, 0
    v_accvgpr_write_b32 a2, 0
    v_accvgpr_write_b32 a3, 0
    v_accvgpr_write_b32 a4, 0
    v_accvgpr_write_b32 a5, 0
    v_accvgpr_write_b32 a6, 0
    v_accvgpr_write_b32 a7, 0
    v_accvgpr_write_b32 a8, 0
    v_accvgpr_write_b32 a9, 0
    v_accvgpr_write_b32 a10, 0
    v_accvgpr_write_b32 a11, 0
    v_accvgpr_write_b32 a12, 0
    v_accvgpr_write_b32 a13, 0
    v_accvgpr_write_b32 a14, 0
    v_accvgpr_write_b32 a15, 0
    v_accvgpr_write_b32 a16, 0
    v_accvgpr_write_b32 a17, 0
    v_accvgpr_write_b32 a18, 0
    v_accvgpr_write_b32 a19, 0
    v_accvgpr_write_b32 a20, 0
    v_accvgpr_write_b32 a21, 0
    v_accvgpr_write_b32 a22, 0
    v_accvgpr_write_b32 a23, 0
    v_accvgpr_write_b32 a24, 0
    v_accvgpr_write_b32 a25, 0
    v_accvgpr_write_b32 a26, 0
    v_accvgpr_write_b32 a27, 0
    v_accvgpr_write_b32 a28, 0
    v_accvgpr_write_b32 a29, 0
    v_accvgpr_write_b32 a30, 0
    v_accvgpr_write_b32 a31, 0
    v_accvgpr_write_b32 a32, 0
    v_accvgpr_write_b32 a33, 0
    v_accvgpr_write_b32 a34, 0
    v_accvgpr_write_b32 a35, 0
    v_accvgpr_write_b32 a36, 0
    v_accvgpr_write_b32 a37, 0
    v_accvgpr_write_b32 a38, 0
    v_accvgpr_write_b32 a39, 0
    v_accvgpr_write_b32 a40, 0
    v_accvgpr_write_b32 a41, 0
    v_accvgpr_write_b32 a42, 0
    v_accvgpr_write_b32 a43, 0
    v_accvgpr_write_b32 a44, 0
    v_accvgpr_write_b32 a45, 0
    v_accvgpr_write_b32 a46, 0
    v_accvgpr_write_b32 a47, 0
    v_accvgpr_write_b32 a48, 0
    v_accvgpr_write_b32 a49, 0
    v_accvgpr_write_b32 a50, 0
    v_accvgpr_write_b32 a51, 0
    v_accvgpr_write_b32 a52, 0
    v_accvgpr_write_b32 a53, 0
    v_accvgpr_write_b32 a54, 0
    v_accvgpr_write_b32 a55, 0
    v_accvgpr_write_b32 a56, 0
    v_accvgpr_write_b32 a57, 0
    v_accvgpr_write_b32 a58, 0
    v_accvgpr_write_b32 a59, 0
    v_accvgpr_write_b32 a60, 0
    v_accvgpr_write_b32 a61, 0
    v_accvgpr_write_b32 a62, 0
    v_accvgpr_write_b32 a63, 0
    s_waitcnt vmcnt(6)
    v_lshrrev_b32 v9, 2, v0
    v_and_b32 v10, 3, v0
    v_bfe_u32 v8, v9, 1, 3
    v_mul_u32_u24 v9, 896, v9
    v_add_u32 v11, 0, v10
    v_xor_b32 v11, v11, v8
    v_lshl_add_u32 v72, v11, 4, v9
    ds_read_b128 v[16:19], v72
    v_add_u32 v11, 4, v10
    v_xor_b32 v11, v11, v8
    v_lshl_add_u32 v73, v11, 4, v9
    ds_read_b128 v[20:23], v73
    v_add_u32 v11, 8, v10
    v_xor_b32 v11, v11, v8
    v_lshl_add_u32 v74, v11, 4, v9
    ds_read_b128 v[24:27], v74
    v_add_u32 v11, 12, v10
    v_xor_b32 v11, v11, v8
    v_lshl_add_u32 v75, v11, 4, v9
    ds_read_b128 v[28:31], v75
    v_add_u32 v11, 16, v10
    v_xor_b32 v11, v11, v8
    v_lshl_add_u32 v76, v11, 4, v9
    ds_read_b128 v[32:35], v76
    v_add_u32 v11, 20, v10
    v_xor_b32 v11, v11, v8
    v_lshl_add_u32 v77, v11, 4, v9
    ds_read_b128 v[36:39], v77
    v_add_u32 v11, 24, v10
    v_xor_b32 v11, v11, v8
    v_lshl_add_u32 v78, v11, 4, v9
    ds_read_b128 v[40:43], v78
    v_add_u32 v11, 28, v10
    v_xor_b32 v11, v11, v8
    v_lshl_add_u32 v79, v11, 4, v9
    ds_read_b128 v[44:47], v79
    v_add_u32 v11, 32, v10
    v_xor_b32 v11, v11, v8
    v_lshl_add_u32 v80, v11, 4, v9
    ds_read_b128 v[48:51], v80
    v_add_u32 v11, 36, v10
    v_xor_b32 v11, v11, v8
    v_lshl_add_u32 v81, v11, 4, v9
    ds_read_b128 v[52:55], v81
    v_add_u32 v11, 40, v10
    v_xor_b32 v11, v11, v8
    v_lshl_add_u32 v82, v11, 4, v9
    ds_read_b128 v[56:59], v82
    v_add_u32 v11, 44, v10
    v_xor_b32 v11, v11, v8
    v_lshl_add_u32 v83, v11, 4, v9
    ds_read_b128 v[60:63], v83
    v_add_u32 v11, 48, v10
    v_xor_b32 v11, v11, v8
    v_lshl_add_u32 v84, v11, 4, v9
    ds_read_b128 v[64:67], v84
    v_add_u32 v11, 52, v10
    v_xor_b32 v11, v11, v8
    v_lshl_add_u32 v85, v11, 4, v9
    ds_read_b128 v[68:71], v85
    s_mov_b32 s26, 0x3f803f80
    v_mov_b32 v12, 0
    v_mov_b32 v13, 0
    v_mov_b32 v14, 0
    v_mov_b32 v15, 0
    s_waitcnt lgkmcnt(13)
    v_dot2_f32_bf16 v12, v16, s26, v12
    v_dot2_f32_bf16 v14, v16, v16, v14
    v_dot2_f32_bf16 v13, v17, s26, v13
    v_dot2_f32_bf16 v15, v17, v17, v15
    v_dot2_f32_bf16 v12, v18, s26, v12
    v_dot2_f32_bf16 v14, v18, v18, v14
    v_dot2_f32_bf16 v13, v19, s26, v13
    v_dot2_f32_bf16 v15, v19, v19, v15
    s_waitcnt lgkmcnt(12)
    v_dot2_f32_bf16 v12, v20, s26, v12
    v_dot2_f32_bf16 v14, v20, v20, v14
    v_dot2_f32_bf16 v13, v21, s26, v13
    v_dot2_f32_bf16 v15, v21, v21, v15
    v_dot2_f32_bf16 v12, v22, s26, v12
    v_dot2_f32_bf16 v14, v22, v22, v14
    v_dot2_f32_bf16 v13, v23, s26, v13
    v_dot2_f32_bf16 v15, v23, v23, v15
    s_waitcnt lgkmcnt(11)
    v_dot2_f32_bf16 v12, v24, s26, v12
    v_dot2_f32_bf16 v14, v24, v24, v14
    v_dot2_f32_bf16 v13, v25, s26, v13
    v_dot2_f32_bf16 v15, v25, v25, v15
    v_dot2_f32_bf16 v12, v26, s26, v12
    v_dot2_f32_bf16 v14, v26, v26, v14
    v_dot2_f32_bf16 v13, v27, s26, v13
    v_dot2_f32_bf16 v15, v27, v27, v15
    s_waitcnt lgkmcnt(10)
    v_dot2_f32_bf16 v12, v28, s26, v12
    v_dot2_f32_bf16 v14, v28, v28, v14
    v_dot2_f32_bf16 v13, v29, s26, v13
    v_dot2_f32_bf16 v15, v29, v29, v15
    v_dot2_f32_bf16 v12, v30, s26, v12
    v_dot2_f32_bf16 v14, v30, v30, v14
    v_dot2_f32_bf16 v13, v31, s26, v13
    v_dot2_f32_bf16 v15, v31, v31, v15
    s_waitcnt lgkmcnt(9)
    v_dot2_f32_bf16 v12, v32, s26, v12
    v_dot2_f32_bf16 v14, v32, v32, v14
    v_dot2_f32_bf16 v13, v33, s26, v13
    v_dot2_f32_bf16 v15, v33, v33, v15
    v_dot2_f32_bf16 v12, v34, s26, v12
    v_dot2_f32_bf16 v14, v34, v34, v14
    v_dot2_f32_bf16 v13, v35, s26, v13
    v_dot2_f32_bf16 v15, v35, v35, v15
    s_waitcnt lgkmcnt(8)
    v_dot2_f32_bf16 v12, v36, s26, v12
    v_dot2_f32_bf16 v14, v36, v36, v14
    v_dot2_f32_bf16 v13, v37, s26, v13
    v_dot2_f32_bf16 v15, v37, v37, v15
    v_dot2_f32_bf16 v12, v38, s26, v12
    v_dot2_f32_bf16 v14, v38, v38, v14
    v_dot2_f32_bf16 v13, v39, s26, v13
    v_dot2_f32_bf16 v15, v39, v39, v15
    s_waitcnt lgkmcnt(7)
    v_dot2_f32_bf16 v12, v40, s26, v12
    v_dot2_f32_bf16 v14, v40, v40, v14
    v_dot2_f32_bf16 v13, v41, s26, v13
    v_dot2_f32_bf16 v15, v41, v41, v15
    v_dot2_f32_bf16 v12, v42, s26, v12
    v_dot2_f32_bf16 v14, v42, v42, v14
    v_dot2_f32_bf16 v13, v43, s26, v13
    v_dot2_f32_bf16 v15, v43, v43, v15
    s_waitcnt lgkmcnt(6)
    v_dot2_f32_bf16 v12, v44, s26, v12
    v_dot2_f32_bf16 v14, v44, v44, v14
    v_dot2_f32_bf16 v13, v45, s26, v13
    v_dot2_f32_bf16 v15, v45, v45, v15
    v_dot2_f32_bf16 v12, v46, s26, v12
    v_dot2_f32_bf16 v14, v46, v46, v14
    v_dot2_f32_bf16 v13, v47, s26, v13
    v_dot2_f32_bf16 v15, v47, v47, v15
    s_waitcnt lgkmcnt(5)
    v_dot2_f32_bf16 v12, v48, s26, v12
    v_dot2_f32_bf16 v14, v48, v48, v14
    v_dot2_f32_bf16 v13, v49, s26, v13
    v_dot2_f32_bf16 v15, v49, v49, v15
    v_dot2_f32_bf16 v12, v50, s26, v12
    v_dot2_f32_bf16 v14, v50, v50, v14
    v_dot2_f32_bf16 v13, v51, s26, v13
    v_dot2_f32_bf16 v15, v51, v51, v15
    s_waitcnt lgkmcnt(4)
    v_dot2_f32_bf16 v12, v52, s26, v12
    v_dot2_f32_bf16 v14, v52, v52, v14
    v_dot2_f32_bf16 v13, v53, s26, v13
    v_dot2_f32_bf16 v15, v53, v53, v15
    v_dot2_f32_bf16 v12, v54, s26, v12
    v_dot2_f32_bf16 v14, v54, v54, v14
    v_dot2_f32_bf16 v13, v55, s26, v13
    v_dot2_f32_bf16 v15, v55, v55, v15
    s_waitcnt lgkmcnt(3)
    v_dot2_f32_bf16 v12, v56, s26, v12
    v_dot2_f32_bf16 v14, v56, v56, v14
    v_dot2_f32_bf16 v13, v57, s26, v13
    v_dot2_f32_bf16 v15, v57, v57, v15
    v_dot2_f32_bf16 v12, v58, s26, v12
    v_dot2_f32_bf16 v14, v58, v58, v14
    v_dot2_f32_bf16 v13, v59, s26, v13
    v_dot2_f32_bf16 v15, v59, v59, v15
    s_waitcnt lgkmcnt(2)
    v_dot2_f32_bf16 v12, v60, s26, v12
    v_dot2_f32_bf16 v14, v60, v60, v14
    v_dot2_f32_bf16 v13, v61, s26, v13
    v_dot2_f32_bf16 v15, v61, v61, v15
    v_dot2_f32_bf16 v12, v62, s26, v12
    v_dot2_f32_bf16 v14, v62, v62, v14
    v_dot2_f32_bf16 v13, v63, s26, v13
    v_dot2_f32_bf16 v15, v63, v63, v15
    s_waitcnt lgkmcnt(1)
    v_dot2_f32_bf16 v12, v64, s26, v12
    v_dot2_f32_bf16 v14, v64, v64, v14
    v_dot2_f32_bf16 v13, v65, s26, v13
    v_dot2_f32_bf16 v15, v65, v65, v15
    v_dot2_f32_bf16 v12, v66, s26, v12
    v_dot2_f32_bf16 v14, v66, v66, v14
    v_dot2_f32_bf16 v13, v67, s26, v13
    v_dot2_f32_bf16 v15, v67, v67, v15
    s_waitcnt lgkmcnt(0)
    v_dot2_f32_bf16 v12, v68, s26, v12
    v_dot2_f32_bf16 v14, v68, v68, v14
    v_dot2_f32_bf16 v13, v69, s26, v13
    v_dot2_f32_bf16 v15, v69, v69, v15
    v_dot2_f32_bf16 v12, v70, s26, v12
    v_dot2_f32_bf16 v14, v70, v70, v14
    v_dot2_f32_bf16 v13, v71, s26, v13
    v_dot2_f32_bf16 v15, v71, v71, v15
    s_nop 3
    v_add_f32 v12, v12, v13
    v_add_f32 v14, v14, v15
    s_nop 1
    v_add_f32_dpp v12, v12, v12 quad_perm:[1,0,3,2] row_mask:0xf bank_mask:0xf
    v_add_f32_dpp v14, v14, v14 quad_perm:[1,0,3,2] row_mask:0xf bank_mask:0xf
    s_nop 1
    v_add_f32_dpp v12, v12, v12 quad_perm:[2,3,0,1] row_mask:0xf bank_mask:0xf
    v_add_f32_dpp v14, v14, v14 quad_perm:[2,3,0,1] row_mask:0xf bank_mask:0xf
    v_mul_f32 v12, 0.002232142857142857, v12
    v_mul_f32 v14, 0.002232142857142857, v14
    v_fma_f32 v14, -v12, v12, v14
    v_max_f32 v14, 0, v14
    v_add_f32 v14, 1e-05, v14
    v_rsq_f32 v15, v14
    s_nop 0
    v_mul_f32 v14, v12, v15
    v_mov_b32 v88, v15
    v_mov_b32 v89, v15
    v_sub_f32 v90, 0, v14
    v_sub_f32 v91, 0, v14
    v_lshlrev_b32 v92, 16, v16
    v_and_b32 v93, 0xffff0000, v16
    v_pk_fma_f32 v[92:93], v[92:93], v[88:89], v[90:91]
    v_cvt_pk_bf16_f32 v16, v92, v93
    v_lshlrev_b32 v94, 16, v17
    v_and_b32 v95, 0xffff0000, v17
    v_pk_fma_f32 v[94:95], v[94:95], v[88:89], v[90:91]
    v_cvt_pk_bf16_f32 v17, v94, v95
    v_lshlrev_b32 v92, 16, v18
    v_and_b32 v93, 0xffff0000, v18
    v_pk_fma_f32 v[92:93], v[92:93], v[88:89], v[90:91]
    v_cvt_pk_bf16_f32 v18, v92, v93
    v_lshlrev_b32 v94, 16, v19
    v_and_b32 v95, 0xffff0000, v19
    v_pk_fma_f32 v[94:95], v[94:95], v[88:89], v[90:91]
    v_cvt_pk_bf16_f32 v19, v94, v95
    ds_write_b128 v72, v[16:19]
    v_lshlrev_b32 v92, 16, v20
    v_and_b32 v93, 0xffff0000, v20
    v_pk_fma_f32 v[92:93], v[92:93], v[88:89], v[90:91]
    v_cvt_pk_bf16_f32 v20, v92, v93
    v_lshlrev_b32 v94, 16, v21
    v_and_b32 v95, 0xffff0000, v21
    v_pk_fma_f32 v[94:95], v[94:95], v[88:89], v[90:91]
    v_cvt_pk_bf16_f32 v21, v94, v95
    v_lshlrev_b32 v92, 16, v22
    v_and_b32 v93, 0xffff0000, v22
    v_pk_fma_f32 v[92:93], v[92:93], v[88:89], v[90:91]
    v_cvt_pk_bf16_f32 v22, v92, v93
    v_lshlrev_b32 v94, 16, v23
    v_and_b32 v95, 0xffff0000, v23
    v_pk_fma_f32 v[94:95], v[94:95], v[88:89], v[90:91]
    v_cvt_pk_bf16_f32 v23, v94, v95
    ds_write_b128 v73, v[20:23]
    v_lshlrev_b32 v92, 16, v24
    v_and_b32 v93, 0xffff0000, v24
    v_pk_fma_f32 v[92:93], v[92:93], v[88:89], v[90:91]
    v_cvt_pk_bf16_f32 v24, v92, v93
    v_lshlrev_b32 v94, 16, v25
    v_and_b32 v95, 0xffff0000, v25
    v_pk_fma_f32 v[94:95], v[94:95], v[88:89], v[90:91]
    v_cvt_pk_bf16_f32 v25, v94, v95
    v_lshlrev_b32 v92, 16, v26
    v_and_b32 v93, 0xffff0000, v26
    v_pk_fma_f32 v[92:93], v[92:93], v[88:89], v[90:91]
    v_cvt_pk_bf16_f32 v26, v92, v93
    v_lshlrev_b32 v94, 16, v27
    v_and_b32 v95, 0xffff0000, v27
    v_pk_fma_f32 v[94:95], v[94:95], v[88:89], v[90:91]
    v_cvt_pk_bf16_f32 v27, v94, v95
    ds_write_b128 v74, v[24:27]
    v_lshlrev_b32 v92, 16, v28
    v_and_b32 v93, 0xffff0000, v28
    v_pk_fma_f32 v[92:93], v[92:93], v[88:89], v[90:91]
    v_cvt_pk_bf16_f32 v28, v92, v93
    v_lshlrev_b32 v94, 16, v29
    v_and_b32 v95, 0xffff0000, v29
    v_pk_fma_f32 v[94:95], v[94:95], v[88:89], v[90:91]
    v_cvt_pk_bf16_f32 v29, v94, v95
    v_lshlrev_b32 v92, 16, v30
    v_and_b32 v93, 0xffff0000, v30
    v_pk_fma_f32 v[92:93], v[92:93], v[88:89], v[90:91]
    v_cvt_pk_bf16_f32 v30, v92, v93
    v_lshlrev_b32 v94, 16, v31
    v_and_b32 v95, 0xffff0000, v31
    v_pk_fma_f32 v[94:95], v[94:95], v[88:89], v[90:91]
    v_cvt_pk_bf16_f32 v31, v94, v95
    ds_write_b128 v75, v[28:31]
    v_lshlrev_b32 v92, 16, v32
    v_and_b32 v93, 0xffff0000, v32
    v_pk_fma_f32 v[92:93], v[92:93], v[88:89], v[90:91]
    v_cvt_pk_bf16_f32 v32, v92, v93
    v_lshlrev_b32 v94, 16, v33
    v_and_b32 v95, 0xffff0000, v33
    v_pk_fma_f32 v[94:95], v[94:95], v[88:89], v[90:91]
    v_cvt_pk_bf16_f32 v33, v94, v95
    v_lshlrev_b32 v92, 16, v34
    v_and_b32 v93, 0xffff0000, v34
    v_pk_fma_f32 v[92:93], v[92:93], v[88:89], v[90:91]
    v_cvt_pk_bf16_f32 v34, v92, v93
    v_lshlrev_b32 v94, 16, v35
    v_and_b32 v95, 0xffff0000, v35
    v_pk_fma_f32 v[94:95], v[94:95], v[88:89], v[90:91]
    v_cvt_pk_bf16_f32 v35, v94, v95
    ds_write_b128 v76, v[32:35]
    v_lshlrev_b32 v92, 16, v36
    v_and_b32 v93, 0xffff0000, v36
    v_pk_fma_f32 v[92:93], v[92:93], v[88:89], v[90:91]
    v_cvt_pk_bf16_f32 v36, v92, v93
    v_lshlrev_b32 v94, 16, v37
    v_and_b32 v95, 0xffff0000, v37
    v_pk_fma_f32 v[94:95], v[94:95], v[88:89], v[90:91]
    v_cvt_pk_bf16_f32 v37, v94, v95
    v_lshlrev_b32 v92, 16, v38
    v_and_b32 v93, 0xffff0000, v38
    v_pk_fma_f32 v[92:93], v[92:93], v[88:89], v[90:91]
    v_cvt_pk_bf16_f32 v38, v92, v93
    v_lshlrev_b32 v94, 16, v39
    v_and_b32 v95, 0xffff0000, v39
    v_pk_fma_f32 v[94:95], v[94:95], v[88:89], v[90:91]
    v_cvt_pk_bf16_f32 v39, v94, v95
    ds_write_b128 v77, v[36:39]
    v_lshlrev_b32 v92, 16, v40
    v_and_b32 v93, 0xffff0000, v40
    v_pk_fma_f32 v[92:93], v[92:93], v[88:89], v[90:91]
    v_cvt_pk_bf16_f32 v40, v92, v93
    v_lshlrev_b32 v94, 16, v41
    v_and_b32 v95, 0xffff0000, v41
    v_pk_fma_f32 v[94:95], v[94:95], v[88:89], v[90:91]
    v_cvt_pk_bf16_f32 v41, v94, v95
    v_lshlrev_b32 v92, 16, v42
    v_and_b32 v93, 0xffff0000, v42
    v_pk_fma_f32 v[92:93], v[92:93], v[88:89], v[90:91]
    v_cvt_pk_bf16_f32 v42, v92, v93
    v_lshlrev_b32 v94, 16, v43
    v_and_b32 v95, 0xffff0000, v43
    v_pk_fma_f32 v[94:95], v[94:95], v[88:89], v[90:91]
    v_cvt_pk_bf16_f32 v43, v94, v95
    ds_write_b128 v78, v[40:43]
    v_lshlrev_b32 v92, 16, v44
    v_and_b32 v93, 0xffff0000, v44
    v_pk_fma_f32 v[92:93], v[92:93], v[88:89], v[90:91]
    v_cvt_pk_bf16_f32 v44, v92, v93
    v_lshlrev_b32 v94, 16, v45
    v_and_b32 v95, 0xffff0000, v45
    v_pk_fma_f32 v[94:95], v[94:95], v[88:89], v[90:91]
    v_cvt_pk_bf16_f32 v45, v94, v95
    v_lshlrev_b32 v92, 16, v46
    v_and_b32 v93, 0xffff0000, v46
    v_pk_fma_f32 v[92:93], v[92:93], v[88:89], v[90:91]
    v_cvt_pk_bf16_f32 v46, v92, v93
    v_lshlrev_b32 v94, 16, v47
    v_and_b32 v95, 0xffff0000, v47
    v_pk_fma_f32 v[94:95], v[94:95], v[88:89], v[90:91]
    v_cvt_pk_bf16_f32 v47, v94, v95
    ds_write_b128 v79, v[44:47]
    v_lshlrev_b32 v92, 16, v48
    v_and_b32 v93, 0xffff0000, v48
    v_pk_fma_f32 v[92:93], v[92:93], v[88:89], v[90:91]
    v_cvt_pk_bf16_f32 v48, v92, v93
    v_lshlrev_b32 v94, 16, v49
    v_and_b32 v95, 0xffff0000, v49
    v_pk_fma_f32 v[94:95], v[94:95], v[88:89], v[90:91]
    v_cvt_pk_bf16_f32 v49, v94, v95
    v_lshlrev_b32 v92, 16, v50
    v_and_b32 v93, 0xffff0000, v50
    v_pk_fma_f32 v[92:93], v[92:93], v[88:89], v[90:91]
    v_cvt_pk_bf16_f32 v50, v92, v93
    v_lshlrev_b32 v94, 16, v51
    v_and_b32 v95, 0xffff0000, v51
    v_pk_fma_f32 v[94:95], v[94:95], v[88:89], v[90:91]
    v_cvt_pk_bf16_f32 v51, v94, v95
    ds_write_b128 v80, v[48:51]
    v_lshlrev_b32 v92, 16, v52
    v_and_b32 v93, 0xffff0000, v52
    v_pk_fma_f32 v[92:93], v[92:93], v[88:89], v[90:91]
    v_cvt_pk_bf16_f32 v52, v92, v93
    v_lshlrev_b32 v94, 16, v53
    v_and_b32 v95, 0xffff0000, v53
    v_pk_fma_f32 v[94:95], v[94:95], v[88:89], v[90:91]
    v_cvt_pk_bf16_f32 v53, v94, v95
    v_lshlrev_b32 v92, 16, v54
    v_and_b32 v93, 0xffff0000, v54
    v_pk_fma_f32 v[92:93], v[92:93], v[88:89], v[90:91]
    v_cvt_pk_bf16_f32 v54, v92, v93
    v_lshlrev_b32 v94, 16, v55
    v_and_b32 v95, 0xffff0000, v55
    v_pk_fma_f32 v[94:95], v[94:95], v[88:89], v[90:91]
    v_cvt_pk_bf16_f32 v55, v94, v95
    ds_write_b128 v81, v[52:55]
    v_lshlrev_b32 v92, 16, v56
    v_and_b32 v93, 0xffff0000, v56
    v_pk_fma_f32 v[92:93], v[92:93], v[88:89], v[90:91]
    v_cvt_pk_bf16_f32 v56, v92, v93
    v_lshlrev_b32 v94, 16, v57
    v_and_b32 v95, 0xffff0000, v57
    v_pk_fma_f32 v[94:95], v[94:95], v[88:89], v[90:91]
    v_cvt_pk_bf16_f32 v57, v94, v95
    v_lshlrev_b32 v92, 16, v58
    v_and_b32 v93, 0xffff0000, v58
    v_pk_fma_f32 v[92:93], v[92:93], v[88:89], v[90:91]
    v_cvt_pk_bf16_f32 v58, v92, v93
    v_lshlrev_b32 v94, 16, v59
    v_and_b32 v95, 0xffff0000, v59
    v_pk_fma_f32 v[94:95], v[94:95], v[88:89], v[90:91]
    v_cvt_pk_bf16_f32 v59, v94, v95
    ds_write_b128 v82, v[56:59]
    v_lshlrev_b32 v92, 16, v60
    v_and_b32 v93, 0xffff0000, v60
    v_pk_fma_f32 v[92:93], v[92:93], v[88:89], v[90:91]
    v_cvt_pk_bf16_f32 v60, v92, v93
    v_lshlrev_b32 v94, 16, v61
    v_and_b32 v95, 0xffff0000, v61
    v_pk_fma_f32 v[94:95], v[94:95], v[88:89], v[90:91]
    v_cvt_pk_bf16_f32 v61, v94, v95
    v_lshlrev_b32 v92, 16, v62
    v_and_b32 v93, 0xffff0000, v62
    v_pk_fma_f32 v[92:93], v[92:93], v[88:89], v[90:91]
    v_cvt_pk_bf16_f32 v62, v92, v93
    v_lshlrev_b32 v94, 16, v63
    v_and_b32 v95, 0xffff0000, v63
    v_pk_fma_f32 v[94:95], v[94:95], v[88:89], v[90:91]
    v_cvt_pk_bf16_f32 v63, v94, v95
    ds_write_b128 v83, v[60:63]
    v_lshlrev_b32 v92, 16, v64
    v_and_b32 v93, 0xffff0000, v64
    v_pk_fma_f32 v[92:93], v[92:93], v[88:89], v[90:91]
    v_cvt_pk_bf16_f32 v64, v92, v93
    v_lshlrev_b32 v94, 16, v65
    v_and_b32 v95, 0xffff0000, v65
    v_pk_fma_f32 v[94:95], v[94:95], v[88:89], v[90:91]
    v_cvt_pk_bf16_f32 v65, v94, v95
    v_lshlrev_b32 v92, 16, v66
    v_and_b32 v93, 0xffff0000, v66
    v_pk_fma_f32 v[92:93], v[92:93], v[88:89], v[90:91]
    v_cvt_pk_bf16_f32 v66, v92, v93
    v_lshlrev_b32 v94, 16, v67
    v_and_b32 v95, 0xffff0000, v67
    v_pk_fma_f32 v[94:95], v[94:95], v[88:89], v[90:91]
    v_cvt_pk_bf16_f32 v67, v94, v95
    ds_write_b128 v84, v[64:67]
    v_lshlrev_b32 v92, 16, v68
    v_and_b32 v93, 0xffff0000, v68
    v_pk_fma_f32 v[92:93], v[92:93], v[88:89], v[90:91]
    v_cvt_pk_bf16_f32 v68, v92, v93
    v_lshlrev_b32 v94, 16, v69
    v_and_b32 v95, 0xffff0000, v69
    v_pk_fma_f32 v[94:95], v[94:95], v[88:89], v[90:91]
    v_cvt_pk_bf16_f32 v69, v94, v95
    v_lshlrev_b32 v92, 16, v70
    v_and_b32 v93, 0xffff0000, v70
    v_pk_fma_f32 v[92:93], v[92:93], v[88:89], v[90:91]
    v_cvt_pk_bf16_f32 v70, v92, v93
    v_lshlrev_b32 v94, 16, v71
    v_and_b32 v95, 0xffff0000, v71
    v_pk_fma_f32 v[94:95], v[94:95], v[88:89], v[90:91]
    v_cvt_pk_bf16_f32 v71, v94, v95
    ds_write_b128 v85, v[68:71]
    s_waitcnt lgkmcnt(0)
    s_barrier
    ds_read_b128 v[16:19], v158 offset:0
    ds_read_b128 v[20:23], v159 offset:0
    ds_read_b128 v[24:27], v160 offset:0
    ds_read_b128 v[28:31], v161 offset:0
    ds_read_b128 v[32:35], v158 offset:128
    ds_read_b128 v[36:39], v159 offset:128
    ds_read_b128 v[40:43], v160 offset:128
    ds_read_b128 v[44:47], v161 offset:128
    ds_read_b128 v[48:51], v158 offset:256
    ds_read_b128 v[52:55], v159 offset:256
    ds_read_b128 v[56:59], v160 offset:256
    ds_read_b128 v[60:63], v161 offset:256
    ds_read_b128 v[64:67], v158 offset:384
    ds_read_b128 v[68:71], v159 offset:384
    ds_read_b128 v[72:75], v160 offset:384
    ds_read_b128 v[76:79], v161 offset:384
    ds_read_b128 v[80:83], v158 offset:512
    ds_read_b128 v[84:87], v159 offset:512
    ds_read_b128 v[88:91], v160 offset:512
    ds_read_b128 v[92:95], v161 offset:512
    ds_read_b128 v[96:99], v158 offset:640
    ds_read_b128 v[100:103], v159 offset:640
    ds_read_b128 v[104:107], v160 offset:640
    ds_read_b128 v[108:111], v161 offset:640
    ds_read_b128 v[112:115], v158 offset:768
    ds_read_b128 v[116:119], v159 offset:768
    ds_read_b128 v[120:123], v160 offset:768
    ds_read_b128 v[124:127], v161 offset:768
    s_waitcnt lgkmcnt(0)
    s_waitcnt vmcnt(2)
    s_barrier
    ds_read_b64_tr_b16 v[128:129], v152 offset:0
    ds_read_b64_tr_b16 v[130:131], v152 offset:1024
    ds_read_b64_tr_b16 v[132:133], v153 offset:0
    ds_read_b64_tr_b16 v[134:135], v153 offset:1024
    ds_read_b64_tr_b16 v[136:137], v152 offset:8192
    ds_read_b64_tr_b16 v[138:139], v152 offset:9216
    ds_read_b64_tr_b16 v[140:141], v153 offset:8192
    ds_read_b64_tr_b16 v[142:143], v153 offset:9216
    ds_read_b64_tr_b16 v[144:145], v152 offset:4096
    ds_read_b64_tr_b16 v[146:147], v152 offset:5120
    s_mov_b32 s48, 344064
    s_add_u32 m0, s51, 0
    s_nop 0
    buffer_load_dwordx4 v162, s[32:35], s48 offen lds
    s_mov_b32 s48, 344064
    s_add_u32 m0, s51, 8192
    s_nop 0
    buffer_load_dwordx4 v162, s[36:39], s48 offen lds
    s_mov_b32 s48, 458752
    s_add_u32 m0, s51, 16384
    s_nop 0
    buffer_load_dwordx4 v162, s[32:35], s48 offen lds
    s_mov_b32 s48, 458752
    s_add_u32 m0, s51, 24576
    s_nop 0
    buffer_load_dwordx4 v162, s[36:39], s48 offen lds
    s_mov_b32 s48, 573440
    s_add_u32 m0, s51, 32768
    s_nop 0
    buffer_load_dwordx4 v162, s[32:35], s48 offen lds
    s_mov_b32 s48, 573440
    s_add_u32 m0, s51, 40960
    s_nop 0
    buffer_load_dwordx4 v162, s[36:39], s48 offen lds
    s_mov_b32 s48, 688128
    s_add_u32 m0, s51, 49152
    s_nop 0
    buffer_load_dwordx4 v162, s[32:35], s48 offen lds
    s_mov_b32 s48, 688128
    s_add_u32 m0, s51, 57344
    s_nop 0
    buffer_load_dwordx4 v162, s[36:39], s48 offen lds
    s_mov_b32 s48, 802816
    s_add_u32 m0, s51, 65536
    s_nop 0
    buffer_load_dwordx4 v162, s[32:35], s48 offen lds
    s_mov_b32 s48, 802816
    s_add_u32 m0, s51, 73728
    s_nop 0
    buffer_load_dwordx4 v162, s[36:39], s48 offen lds
    s_mov_b32 s48, 917504
    s_add_u32 m0, s51, 81920
    s_nop 0
    buffer_load_dwordx4 v162, s[32:35], s48 offen lds
    s_mov_b32 s48, 917504
    s_add_u32 m0, s51, 90112
    s_nop 0
    buffer_load_dwordx4 v162, s[36:39], s48 offen lds
    s_mov_b32 s48, 1032192
    s_add_u32 m0, s51, 98304
    s_nop 0
    buffer_load_dwordx4 v162, s[32:35], s48 offen lds
    s_mov_b32 s48, 1032192
    s_add_u32 m0, s51, 106496
    s_nop 0
    buffer_load_dwordx4 v162, s[36:39], s48 offen lds
    ds_read_b64_tr_b16 v[148:149], v153 offset:4096
    ds_read_b64_tr_b16 v[150:151], v153 offset:5120
    s_waitcnt lgkmcnt(10)
    v_mfma_f32_32x32x16_bf16 a[0:15], v[128:131], v[16:19], a[0:15]
    ds_read_b64_tr_b16 v[128:129], v152 offset:12288
    ds_read_b64_tr_b16 v[130:131], v152 offset:13312
    s_waitcnt lgkmcnt(10)
    v_mfma_f32_32x32x16_bf16 a[16:31], v[132:135], v[16:19], a[16:31]
    ds_read_b64_tr_b16 v[132:133], v153 offset:12288
    ds_read_b64_tr_b16 v[134:135], v153 offset:13312
    s_waitcnt lgkmcnt(10)
    v_mfma_f32_32x32x16_bf16 a[32:47], v[136:139], v[16:19], a[32:47]
    ds_read_b64_tr_b16 v[136:137], v152 offset:16384
    ds_read_b64_tr_b16 v[138:139], v152 offset:17408
    s_waitcnt lgkmcnt(10)
    v_mfma_f32_32x32x16_bf16 a[48:63], v[140:143], v[16:19], a[48:63]
    ds_read_b64_tr_b16 v[140:141], v153 offset:16384
    ds_read_b64_tr_b16 v[142:143], v153 offset:17408
    s_waitcnt lgkmcnt(10)
    v_mfma_f32_32x32x16_bf16 a[0:15], v[144:147], v[20:23], a[0:15]
    ds_read_b64_tr_b16 v[144:145], v152 offset:24576
    ds_read_b64_tr_b16 v[146:147], v152 offset:25600
    s_waitcnt lgkmcnt(10)
    v_mfma_f32_32x32x16_bf16 a[16:31], v[148:151], v[20:23], a[16:31]
    ds_read_b64_tr_b16 v[148:149], v153 offset:24576
    ds_read_b64_tr_b16 v[150:151], v153 offset:25600
    s_waitcnt lgkmcnt(10)
    v_mfma_f32_32x32x16_bf16 a[32:47], v[128:131], v[20:23], a[32:47]
    ds_read_b64_tr_b16 v[128:129], v152 offset:20480
    ds_read_b64_tr_b16 v[130:131], v152 offset:21504
    s_waitcnt lgkmcnt(10)
    v_mfma_f32_32x32x16_bf16 a[48:63], v[132:135], v[20:23], a[48:63]
    s_waitcnt vmcnt(14)
    s_barrier
    s_mov_b32 s48, 1146880
    s_add_u32 m0, s51, 114688
    s_nop 0
    buffer_load_dwordx4 v162, s[32:35], s48 offen lds
    s_mov_b32 s48, 1146880
    s_add_u32 m0, s51, 122880
    s_nop 0
    buffer_load_dwordx4 v162, s[36:39], s48 offen lds
    ds_read_b64_tr_b16 v[132:133], v153 offset:20480
    ds_read_b64_tr_b16 v[134:135], v153 offset:21504
    s_waitcnt lgkmcnt(10)
    v_mfma_f32_32x32x16_bf16 a[0:15], v[136:139], v[24:27], a[0:15]
    ds_read_b64_tr_b16 v[136:137], v152 offset:28672
    ds_read_b64_tr_b16 v[138:139], v152 offset:29696
    s_waitcnt lgkmcnt(10)
    v_mfma_f32_32x32x16_bf16 a[16:31], v[140:143], v[24:27], a[16:31]
    ds_read_b64_tr_b16 v[140:141], v153 offset:28672
    ds_read_b64_tr_b16 v[142:143], v153 offset:29696
    s_waitcnt lgkmcnt(10)
    v_mfma_f32_32x32x16_bf16 a[32:47], v[144:147], v[24:27], a[32:47]
    ds_read_b64_tr_b16 v[144:145], v152 offset:32768
    ds_read_b64_tr_b16 v[146:147], v152 offset:33792
    s_waitcnt lgkmcnt(10)
    v_mfma_f32_32x32x16_bf16 a[48:63], v[148:151], v[24:27], a[48:63]
    ds_read_b64_tr_b16 v[148:149], v153 offset:32768
    ds_read_b64_tr_b16 v[150:151], v153 offset:33792
    s_waitcnt lgkmcnt(10)
    v_mfma_f32_32x32x16_bf16 a[0:15], v[128:131], v[28:31], a[0:15]
    ds_read_b64_tr_b16 v[128:129], v152 offset:40960
    ds_read_b64_tr_b16 v[130:131], v152 offset:41984
    s_waitcnt lgkmcnt(10)
    v_mfma_f32_32x32x16_bf16 a[16:31], v[132:135], v[28:31], a[16:31]
    ds_read_b64_tr_b16 v[132:133], v153 offset:40960
    ds_read_b64_tr_b16 v[134:135], v153 offset:41984
    s_waitcnt lgkmcnt(10)
    v_mfma_f32_32x32x16_bf16 a[32:47], v[136:139], v[28:31], a[32:47]
    ds_read_b64_tr_b16 v[136:137], v152 offset:36864
    ds_read_b64_tr_b16 v[138:139], v152 offset:37888
    s_waitcnt lgkmcnt(10)
    v_mfma_f32_32x32x16_bf16 a[48:63], v[140:143], v[28:31], a[48:63]
    s_waitcnt vmcnt(14)
    s_barrier
    s_mov_b32 s48, 1261568
    s_add_u32 m0, s51, 131072
    s_nop 0
    buffer_load_dwordx4 v162, s[32:35], s48 offen lds
    s_mov_b32 s48, 1261568
    s_add_u32 m0, s51, 139264
    s_nop 0
    buffer_load_dwordx4 v162, s[36:39], s48 offen lds
    ds_read_b64_tr_b16 v[140:141], v153 offset:36864
    ds_read_b64_tr_b16 v[142:143], v153 offset:37888
    s_waitcnt lgkmcnt(10)
    v_mfma_f32_32x32x16_bf16 a[0:15], v[144:147], v[32:35], a[0:15]
    ds_read_b64_tr_b16 v[144:145], v152 offset:45056
    ds_read_b64_tr_b16 v[146:147], v152 offset:46080
    s_waitcnt lgkmcnt(10)
    v_mfma_f32_32x32x16_bf16 a[16:31], v[148:151], v[32:35], a[16:31]
    ds_read_b64_tr_b16 v[148:149], v153 offset:45056
    ds_read_b64_tr_b16 v[150:151], v153 offset:46080
    s_waitcnt lgkmcnt(10)
    v_mfma_f32_32x32x16_bf16 a[32:47], v[128:131], v[32:35], a[32:47]
    ds_read_b64_tr_b16 v[128:129], v154 offset:0
    ds_read_b64_tr_b16 v[130:131], v154 offset:1024
    s_waitcnt lgkmcnt(10)
    v_mfma_f32_32x32x16_bf16 a[48:63], v[132:135], v[32:35], a[48:63]
    ds_read_b64_tr_b16 v[132:133], v155 offset:0
    ds_read_b64_tr_b16 v[134:135], v155 offset:1024
    s_waitcnt lgkmcnt(10)
    v_mfma_f32_32x32x16_bf16 a[0:15], v[136:139], v[36:39], a[0:15]
    ds_read_b64_tr_b16 v[136:137], v154 offset:8192
    ds_read_b64_tr_b16 v[138:139], v154 offset:9216
    s_waitcnt lgkmcnt(10)
    v_mfma_f32_32x32x16_bf16 a[16:31], v[140:143], v[36:39], a[16:31]
    ds_read_b64_tr_b16 v[140:141], v155 offset:8192
    ds_read_b64_tr_b16 v[142:143], v155 offset:9216
    s_waitcnt lgkmcnt(10)
    v_mfma_f32_32x32x16_bf16 a[32:47], v[144:147], v[36:39], a[32:47]
    ds_read_b64_tr_b16 v[144:145], v154 offset:4096
    ds_read_b64_tr_b16 v[146:147], v154 offset:5120
    s_waitcnt lgkmcnt(10)
    v_mfma_f32_32x32x16_bf16 a[48:63], v[148:151], v[36:39], a[48:63]
    s_waitcnt vmcnt(14)
    s_barrier
    s_mov_b32 s48, 1376256
    s_add_u32 m0, s51, 147456
    s_nop 0
    buffer_load_dwordx4 v162, s[32:35], s48 offen lds
    s_mov_b32 s48, 1376256
    s_add_u32 m0, s51, 155648
    s_nop 0
    buffer_load_dwordx4 v162, s[36:39], s48 offen lds
    ds_read_b64_tr_b16 v[148:149], v155 offset:4096
    ds_read_b64_tr_b16 v[150:151], v155 offset:5120
    s_waitcnt lgkmcnt(10)
    v_mfma_f32_32x32x16_bf16 a[0:15], v[128:131], v[40:43], a[0:15]
    ds_read_b64_tr_b16 v[128:129], v154 offset:12288
    ds_read_b64_tr_b16 v[130:131], v154 offset:13312
    s_waitcnt lgkmcnt(10)
    v_mfma_f32_32x32x16_bf16 a[16:31], v[132:135], v[40:43], a[16:31]
    ds_read_b64_tr_b16 v[132:133], v155 offset:12288
    ds_read_b64_tr_b16 v[134:135], v155 offset:13312
    s_waitcnt lgkmcnt(10)
    v_mfma_f32_32x32x16_bf16 a[32:47], v[136:139], v[40:43], a[32:47]
    ds_read_b64_tr_b16 v[136:137], v154 offset:16384
    ds_read_b64_tr_b16 v[138:139], v154 offset:17408
    s_waitcnt lgkmcnt(10)
    v_mfma_f32_32x32x16_bf16 a[48:63], v[140:143], v[40:43], a[48:63]
    ds_read_b64_tr_b16 v[140:141], v155 offset:16384
    ds_read_b64_tr_b16 v[142:143], v155 offset:17408
    s_waitcnt lgkmcnt(10)
    v_mfma_f32_32x32x16_bf16 a[0:15], v[144:147], v[44:47], a[0:15]
    ds_read_b64_tr_b16 v[144:145], v154 offset:24576
    ds_read_b64_tr_b16 v[146:147], v154 offset:25600
    s_waitcnt lgkmcnt(10)
    v_mfma_f32_32x32x16_bf16 a[16:31], v[148:151], v[44:47], a[16:31]
    ds_read_b64_tr_b16 v[148:149], v155 offset:24576
    ds_read_b64_tr_b16 v[150:151], v155 offset:25600
    s_waitcnt lgkmcnt(10)
    v_mfma_f32_32x32x16_bf16 a[32:47], v[128:131], v[44:47], a[32:47]
    ds_read_b64_tr_b16 v[128:129], v154 offset:20480
    ds_read_b64_tr_b16 v[130:131], v154 offset:21504
    s_waitcnt lgkmcnt(10)
    v_mfma_f32_32x32x16_bf16 a[48:63], v[132:135], v[44:47], a[48:63]
    s_waitcnt vmcnt(14)
    s_barrier
    s_mov_b32 s48, 1490944
    s_add_u32 m0, s51, 0
    s_nop 0
    buffer_load_dwordx4 v162, s[32:35], s48 offen lds
    s_mov_b32 s48, 1490944
    s_add_u32 m0, s51, 8192
    s_nop 0
    buffer_load_dwordx4 v162, s[36:39], s48 offen lds
    ds_read_b64_tr_b16 v[132:133], v155 offset:20480
    ds_read_b64_tr_b16 v[134:135], v155 offset:21504
    s_waitcnt lgkmcnt(10)
    v_mfma_f32_32x32x16_bf16 a[0:15], v[136:139], v[48:51], a[0:15]
    ds_read_b64_tr_b16 v[136:137], v154 offset:28672
    ds_read_b64_tr_b16 v[138:139], v154 offset:29696
    s_waitcnt lgkmcnt(10)
    v_mfma_f32_32x32x16_bf16 a[16:31], v[140:143], v[48:51], a[16:31]
    ds_read_b64_tr_b16 v[140:141], v155 offset:28672
    ds_read_b64_tr_b16 v[142:143], v155 offset:29696
    s_waitcnt lgkmcnt(10)
    v_mfma_f32_32x32x16_bf16 a[32:47], v[144:147], v[48:51], a[32:47]
    ds_read_b64_tr_b16 v[144:145], v154 offset:32768
    ds_read_b64_tr_b16 v[146:147], v154 offset:33792
    s_waitcnt lgkmcnt(10)
    v_mfma_f32_32x32x16_bf16 a[48:63], v[148:151], v[48:51], a[48:63]
    ds_read_b64_tr_b16 v[148:149], v155 offset:32768
    ds_read_b64_tr_b16 v[150:151], v155 offset:33792
    s_waitcnt lgkmcnt(10)
    v_mfma_f32_32x32x16_bf16 a[0:15], v[128:131], v[52:55], a[0:15]
    ds_read_b64_tr_b16 v[128:129], v154 offset:40960
    ds_read_b64_tr_b16 v[130:131], v154 offset:41984
    s_waitcnt lgkmcnt(10)
    v_mfma_f32_32x32x16_bf16 a[16:31], v[132:135], v[52:55], a[16:31]
    ds_read_b64_tr_b16 v[132:133], v155 offset:40960
    ds_read_b64_tr_b16 v[134:135], v155 offset:41984
    s_waitcnt lgkmcnt(10)
    v_mfma_f32_32x32x16_bf16 a[32:47], v[136:139], v[52:55], a[32:47]
    ds_read_b64_tr_b16 v[136:137], v154 offset:36864
    ds_read_b64_tr_b16 v[138:139], v154 offset:37888
    s_waitcnt lgkmcnt(10)
    v_mfma_f32_32x32x16_bf16 a[48:63], v[140:143], v[52:55], a[48:63]
    s_waitcnt vmcnt(14)
    s_barrier
    ds_read_b64_tr_b16 v[140:141], v155 offset:36864
    ds_read_b64_tr_b16 v[142:143], v155 offset:37888
    s_waitcnt lgkmcnt(10)
    v_mfma_f32_32x32x16_bf16 a[0:15], v[144:147], v[56:59], a[0:15]
    ds_read_b64_tr_b16 v[144:145], v154 offset:45056
    ds_read_b64_tr_b16 v[146:147], v154 offset:46080
    s_waitcnt lgkmcnt(10)
    v_mfma_f32_32x32x16_bf16 a[16:31], v[148:151], v[56:59], a[16:31]
    ds_read_b64_tr_b16 v[148:149], v155 offset:45056
    ds_read_b64_tr_b16 v[150:151], v155 offset:46080
    s_waitcnt lgkmcnt(10)
    v_mfma_f32_32x32x16_bf16 a[32:47], v[128:131], v[56:59], a[32:47]
    ds_read_b64_tr_b16 v[128:129], v154 offset:49152
    ds_read_b64_tr_b16 v[130:131], v154 offset:50176
    s_waitcnt lgkmcnt(10)
    v_mfma_f32_32x32x16_bf16 a[48:63], v[132:135], v[56:59], a[48:63]
    ds_read_b64_tr_b16 v[132:133], v155 offset:49152
    ds_read_b64_tr_b16 v[134:135], v155 offset:50176
    s_waitcnt lgkmcnt(10)
    v_mfma_f32_32x32x16_bf16 a[0:15], v[136:139], v[60:63], a[0:15]
    ds_read_b64_tr_b16 v[136:137], v154 offset:57344
    ds_read_b64_tr_b16 v[138:139], v154 offset:58368
    s_waitcnt lgkmcnt(10)
    v_mfma_f32_32x32x16_bf16 a[16:31], v[140:143], v[60:63], a[16:31]
    ds_read_b64_tr_b16 v[140:141], v155 offset:57344
    ds_read_b64_tr_b16 v[142:143], v155 offset:58368
    s_waitcnt lgkmcnt(10)
    v_mfma_f32_32x32x16_bf16 a[32:47], v[144:147], v[60:63], a[32:47]
    ds_read_b64_tr_b16 v[144:145], v154 offset:53248
    ds_read_b64_tr_b16 v[146:147], v154 offset:54272
    s_waitcnt lgkmcnt(10)
    v_mfma_f32_32x32x16_bf16 a[48:63], v[148:151], v[60:63], a[48:63]
    s_waitcnt vmcnt(12)
    s_barrier
    ds_read_b64_tr_b16 v[148:149], v155 offset:53248
    ds_read_b64_tr_b16 v[150:151], v155 offset:54272
    s_waitcnt lgkmcnt(10)
    v_mfma_f32_32x32x16_bf16 a[0:15], v[128:131], v[64:67], a[0:15]
    ds_read_b64_tr_b16 v[128:129], v154 offset:61440
    ds_read_b64_tr_b16 v[130:131], v154 offset:62464
    s_waitcnt lgkmcnt(10)
    v_mfma_f32_32x32x16_bf16 a[16:31], v[132:135], v[64:67], a[16:31]
    ds_read_b64_tr_b16 v[132:133], v155 offset:61440
    ds_read_b64_tr_b16 v[134:135], v155 offset:62464
    s_waitcnt lgkmcnt(10)
    v_mfma_f32_32x32x16_bf16 a[32:47], v[136:139], v[64:67], a[32:47]
    ds_read_b64_tr_b16 v[136:137], v156 offset:0
    ds_read_b64_tr_b16 v[138:139], v156 offset:1024
    s_waitcnt lgkmcnt(10)
    v_mfma_f32_32x32x16_bf16 a[48:63], v[140:143], v[64:67], a[48:63]
    ds_read_b64_tr_b16 v[140:141], v157 offset:0
    ds_read_b64_tr_b16 v[142:143], v157 offset:1024
    s_waitcnt lgkmcnt(10)
    v_mfma_f32_32x32x16_bf16 a[0:15], v[144:147], v[68:71], a[0:15]
    ds_read_b64_tr_b16 v[144:145], v156 offset:8192
    ds_read_b64_tr_b16 v[146:147], v156 offset:9216
    s_waitcnt lgkmcnt(10)
    v_mfma_f32_32x32x16_bf16 a[16:31], v[148:151], v[68:71], a[16:31]
    ds_read_b64_tr_b16 v[148:149], v157 offset:8192
    ds_read_b64_tr_b16 v[150:151], v157 offset:9216
    s_waitcnt lgkmcnt(10)
    v_mfma_f32_32x32x16_bf16 a[32:47], v[128:131], v[68:71], a[32:47]
    ds_read_b64_tr_b16 v[128:129], v156 offset:4096
    ds_read_b64_tr_b16 v[130:131], v156 offset:5120
    s_waitcnt lgkmcnt(10)
    v_mfma_f32_32x32x16_bf16 a[48:63], v[132:135], v[68:71], a[48:63]
    s_waitcnt vmcnt(10)
    s_barrier
    ds_read_b64_tr_b16 v[132:133], v157 offset:4096
    ds_read_b64_tr_b16 v[134:135], v157 offset:5120
    s_waitcnt lgkmcnt(10)
    v_mfma_f32_32x32x16_bf16 a[0:15], v[136:139], v[72:75], a[0:15]
    ds_read_b64_tr_b16 v[136:137], v156 offset:12288
    ds_read_b64_tr_b16 v[138:139], v156 offset:13312
    s_waitcnt lgkmcnt(10)
    v_mfma_f32_32x32x16_bf16 a[16:31], v[140:143], v[72:75], a[16:31]
    ds_read_b64_tr_b16 v[140:141], v157 offset:12288
    ds_read_b64_tr_b16 v[142:143], v157 offset:13312
    s_waitcnt lgkmcnt(10)
    v_mfma_f32_32x32x16_bf16 a[32:47], v[144:147], v[72:75], a[32:47]
    ds_read_b64_tr_b16 v[144:145], v156 offset:16384
    ds_read_b64_tr_b16 v[146:147], v156 offset:17408
    s_waitcnt lgkmcnt(10)
    v_mfma_f32_32x32x16_bf16 a[48:63], v[148:151], v[72:75], a[48:63]
    ds_read_b64_tr_b16 v[148:149], v157 offset:16384
    ds_read_b64_tr_b16 v[150:151], v157 offset:17408
    s_waitcnt lgkmcnt(10)
    v_mfma_f32_32x32x16_bf16 a[0:15], v[128:131], v[76:79], a[0:15]
    ds_read_b64_tr_b16 v[128:129], v156 offset:24576
    ds_read_b64_tr_b16 v[130:131], v156 offset:25600
    s_waitcnt lgkmcnt(10)
    v_mfma_f32_32x32x16_bf16 a[16:31], v[132:135], v[76:79], a[16:31]
    ds_read_b64_tr_b16 v[132:133], v157 offset:24576
    ds_read_b64_tr_b16 v[134:135], v157 offset:25600
    s_waitcnt lgkmcnt(10)
    v_mfma_f32_32x32x16_bf16 a[32:47], v[136:139], v[76:79], a[32:47]
    ds_read_b64_tr_b16 v[136:137], v156 offset:20480
    ds_read_b64_tr_b16 v[138:139], v156 offset:21504
    s_waitcnt lgkmcnt(10)
    v_mfma_f32_32x32x16_bf16 a[48:63], v[140:143], v[76:79], a[48:63]
    s_waitcnt vmcnt(8)
    s_barrier
    ds_read_b64_tr_b16 v[140:141], v157 offset:20480
    ds_read_b64_tr_b16 v[142:143], v157 offset:21504
    s_waitcnt lgkmcnt(10)
    v_mfma_f32_32x32x16_bf16 a[0:15], v[144:147], v[80:83], a[0:15]
    ds_read_b64_tr_b16 v[144:145], v156 offset:28672
    ds_read_b64_tr_b16 v[146:147], v156 offset:29696
    s_waitcnt lgkmcnt(10)
    v_mfma_f32_32x32x16_bf16 a[16:31], v[148:151], v[80:83], a[16:31]
    ds_read_b64_tr_b16 v[148:149], v157 offset:28672
    ds_read_b64_tr_b16 v[150:151], v157 offset:29696
    s_waitcnt lgkmcnt(10)
    v_mfma_f32_32x32x16_bf16 a[32:47], v[128:131], v[80:83], a[32:47]
    ds_read_b64_tr_b16 v[128:129], v156 offset:32768
    ds_read_b64_tr_b16 v[130:131], v156 offset:33792
    s_waitcnt lgkmcnt(10)
    v_mfma_f32_32x32x16_bf16 a[48:63], v[132:135], v[80:83], a[48:63]
    ds_read_b64_tr_b16 v[132:133], v157 offset:32768
    ds_read_b64_tr_b16 v[134:135], v157 offset:33792
    s_waitcnt lgkmcnt(10)
    v_mfma_f32_32x32x16_bf16 a[0:15], v[136:139], v[84:87], a[0:15]
    ds_read_b64_tr_b16 v[136:137], v156 offset:40960
    ds_read_b64_tr_b16 v[138:139], v156 offset:41984
    s_waitcnt lgkmcnt(10)
    v_mfma_f32_32x32x16_bf16 a[16:31], v[140:143], v[84:87], a[16:31]
    ds_read_b64_tr_b16 v[140:141], v157 offset:40960
    ds_read_b64_tr_b16 v[142:143], v157 offset:41984
    s_waitcnt lgkmcnt(10)
    v_mfma_f32_32x32x16_bf16 a[32:47], v[144:147], v[84:87], a[32:47]
    ds_read_b64_tr_b16 v[144:145], v156 offset:36864
    ds_read_b64_tr_b16 v[146:147], v156 offset:37888
    s_waitcnt lgkmcnt(10)
    v_mfma_f32_32x32x16_bf16 a[48:63], v[148:151], v[84:87], a[48:63]
    s_waitcnt vmcnt(6)
    s_barrier
    ds_read_b64_tr_b16 v[148:149], v157 offset:36864
    ds_read_b64_tr_b16 v[150:151], v157 offset:37888
    s_waitcnt lgkmcnt(10)
    v_mfma_f32_32x32x16_bf16 a[0:15], v[128:131], v[88:91], a[0:15]
    ds_read_b64_tr_b16 v[128:129], v156 offset:45056
    ds_read_b64_tr_b16 v[130:131], v156 offset:46080
    s_waitcnt lgkmcnt(10)
    v_mfma_f32_32x32x16_bf16 a[16:31], v[132:135], v[88:91], a[16:31]
    ds_read_b64_tr_b16 v[132:133], v157 offset:45056
    ds_read_b64_tr_b16 v[134:135], v157 offset:46080
    s_waitcnt lgkmcnt(10)
    v_mfma_f32_32x32x16_bf16 a[32:47], v[136:139], v[88:91], a[32:47]
    ds_read_b64_tr_b16 v[136:137], v152 offset:0
    ds_read_b64_tr_b16 v[138:139], v152 offset:1024
    s_waitcnt lgkmcnt(10)
    v_mfma_f32_32x32x16_bf16 a[48:63], v[140:143], v[88:91], a[48:63]
    ds_read_b64_tr_b16 v[140:141], v153 offset:0
    ds_read_b64_tr_b16 v[142:143], v153 offset:1024
    s_waitcnt lgkmcnt(10)
    v_mfma_f32_32x32x16_bf16 a[0:15], v[144:147], v[92:95], a[0:15]
    ds_read_b64_tr_b16 v[144:145], v152 offset:8192
    ds_read_b64_tr_b16 v[146:147], v152 offset:9216
    s_waitcnt lgkmcnt(10)
    v_mfma_f32_32x32x16_bf16 a[16:31], v[148:151], v[92:95], a[16:31]
    ds_read_b64_tr_b16 v[148:149], v153 offset:8192
    ds_read_b64_tr_b16 v[150:151], v153 offset:9216
    s_waitcnt lgkmcnt(10)
    v_mfma_f32_32x32x16_bf16 a[32:47], v[128:131], v[92:95], a[32:47]
    ds_read_b64_tr_b16 v[128:129], v152 offset:4096
    ds_read_b64_tr_b16 v[130:131], v152 offset:5120
    s_waitcnt lgkmcnt(10)
    v_mfma_f32_32x32x16_bf16 a[48:63], v[132:135], v[92:95], a[48:63]
    s_waitcnt vmcnt(4)
    s_barrier
    ds_read_b64_tr_b16 v[132:133], v153 offset:4096
    ds_read_b64_tr_b16 v[134:135], v153 offset:5120
    s_waitcnt lgkmcnt(10)
    v_mfma_f32_32x32x16_bf16 a[0:15], v[136:139], v[96:99], a[0:15]
    ds_read_b64_tr_b16 v[136:137], v152 offset:12288
    ds_read_b64_tr_b16 v[138:139], v152 offset:13312
    s_waitcnt lgkmcnt(10)
    v_mfma_f32_32x32x16_bf16 a[16:31], v[140:143], v[96:99], a[16:31]
    ds_read_b64_tr_b16 v[140:141], v153 offset:12288
    ds_read_b64_tr_b16 v[142:143], v153 offset:13312
    s_waitcnt lgkmcnt(10)
    v_mfma_f32_32x32x16_bf16 a[32:47], v[144:147], v[96:99], a[32:47]
    ds_read_b64_tr_b16 v[144:145], v152 offset:16384
    ds_read_b64_tr_b16 v[146:147], v152 offset:17408
    s_waitcnt lgkmcnt(10)
    v_mfma_f32_32x32x16_bf16 a[48:63], v[148:151], v[96:99], a[48:63]
    ds_read_b64_tr_b16 v[148:149], v153 offset:16384
    ds_read_b64_tr_b16 v[150:151], v153 offset:17408
    s_waitcnt lgkmcnt(10)
    v_mfma_f32_32x32x16_bf16 a[0:15], v[128:131], v[100:103], a[0:15]
    ds_read_b64_tr_b16 v[128:129], v152 offset:24576
    ds_read_b64_tr_b16 v[130:131], v152 offset:25600
    s_waitcnt lgkmcnt(10)
    v_mfma_f32_32x32x16_bf16 a[16:31], v[132:135], v[100:103], a[16:31]
    ds_read_b64_tr_b16 v[132:133], v153 offset:24576
    ds_read_b64_tr_b16 v[134:135], v153 offset:25600
    s_waitcnt lgkmcnt(10)
    v_mfma_f32_32x32x16_bf16 a[32:47], v[136:139], v[100:103], a[32:47]
    ds_read_b64_tr_b16 v[136:137], v152 offset:20480
    ds_read_b64_tr_b16 v[138:139], v152 offset:21504
    s_waitcnt lgkmcnt(10)
    v_mfma_f32_32x32x16_bf16 a[48:63], v[140:143], v[100:103], a[48:63]
    s_waitcnt vmcnt(2)
    s_barrier
    ds_read_b64_tr_b16 v[140:141], v153 offset:20480
    ds_read_b64_tr_b16 v[142:143], v153 offset:21504
    s_waitcnt lgkmcnt(10)
    v_mfma_f32_32x32x16_bf16 a[0:15], v[144:147], v[104:107], a[0:15]
    ds_read_b64_tr_b16 v[144:145], v152 offset:28672
    ds_read_b64_tr_b16 v[146:147], v152 offset:29696
    s_waitcnt lgkmcnt(10)
    v_mfma_f32_32x32x16_bf16 a[16:31], v[148:151], v[104:107], a[16:31]
    ds_read_b64_tr_b16 v[148:149], v153 offset:28672
    ds_read_b64_tr_b16 v[150:151], v153 offset:29696
    s_waitcnt lgkmcnt(10)
    v_mfma_f32_32x32x16_bf16 a[32:47], v[128:131], v[104:107], a[32:47]
    ds_read_b64_tr_b16 v[128:129], v152 offset:32768
    ds_read_b64_tr_b16 v[130:131], v152 offset:33792
    s_waitcnt lgkmcnt(10)
    v_mfma_f32_32x32x16_bf16 a[48:63], v[132:135], v[104:107], a[48:63]
    ds_read_b64_tr_b16 v[132:133], v153 offset:32768
    ds_read_b64_tr_b16 v[134:135], v153 offset:33792
    s_waitcnt lgkmcnt(10)
    v_mfma_f32_32x32x16_bf16 a[0:15], v[136:139], v[108:111], a[0:15]
    ds_read_b64_tr_b16 v[136:137], v152 offset:40960
    ds_read_b64_tr_b16 v[138:139], v152 offset:41984
    s_waitcnt lgkmcnt(10)
    v_mfma_f32_32x32x16_bf16 a[16:31], v[140:143], v[108:111], a[16:31]
    ds_read_b64_tr_b16 v[140:141], v153 offset:40960
    ds_read_b64_tr_b16 v[142:143], v153 offset:41984
    s_waitcnt lgkmcnt(10)
    v_mfma_f32_32x32x16_bf16 a[32:47], v[144:147], v[108:111], a[32:47]
    ds_read_b64_tr_b16 v[144:145], v152 offset:36864
    ds_read_b64_tr_b16 v[146:147], v152 offset:37888
    s_waitcnt lgkmcnt(10)
    v_mfma_f32_32x32x16_bf16 a[48:63], v[148:151], v[108:111], a[48:63]
    s_waitcnt vmcnt(0)
    s_barrier
    ds_read_b64_tr_b16 v[148:149], v153 offset:36864
    ds_read_b64_tr_b16 v[150:151], v153 offset:37888
    s_waitcnt lgkmcnt(10)
    v_mfma_f32_32x32x16_bf16 a[0:15], v[128:131], v[112:115], a[0:15]
    ds_read_b64_tr_b16 v[128:129], v152 offset:45056
    ds_read_b64_tr_b16 v[130:131], v152 offset:46080
    s_waitcnt lgkmcnt(10)
    v_mfma_f32_32x32x16_bf16 a[16:31], v[132:135], v[112:115], a[16:31]
    ds_read_b64_tr_b16 v[132:133], v153 offset:45056
    ds_read_b64_tr_b16 v[134:135], v153 offset:46080
    s_waitcnt lgkmcnt(10)
    v_mfma_f32_32x32x16_bf16 a[32:47], v[136:139], v[112:115], a[32:47]
    ds_read_b64_tr_b16 v[136:137], v154 offset:0
    ds_read_b64_tr_b16 v[138:139], v154 offset:1024
    s_waitcnt lgkmcnt(10)
    v_mfma_f32_32x32x16_bf16 a[48:63], v[140:143], v[112:115], a[48:63]
    ds_read_b64_tr_b16 v[140:141], v155 offset:0
    ds_read_b64_tr_b16 v[142:143], v155 offset:1024
    s_waitcnt lgkmcnt(10)
    v_mfma_f32_32x32x16_bf16 a[0:15], v[144:147], v[116:119], a[0:15]
    ds_read_b64_tr_b16 v[144:145], v154 offset:8192
    ds_read_b64_tr_b16 v[146:147], v154 offset:9216
    s_waitcnt lgkmcnt(10)
    v_mfma_f32_32x32x16_bf16 a[16:31], v[148:151], v[116:119], a[16:31]
    ds_read_b64_tr_b16 v[148:149], v155 offset:8192
    ds_read_b64_tr_b16 v[150:151], v155 offset:9216
    s_waitcnt lgkmcnt(10)
    v_mfma_f32_32x32x16_bf16 a[32:47], v[128:131], v[116:119], a[32:47]
    ds_read_b64_tr_b16 v[128:129], v154 offset:4096
    ds_read_b64_tr_b16 v[130:131], v154 offset:5120
    s_waitcnt lgkmcnt(10)
    v_mfma_f32_32x32x16_bf16 a[48:63], v[132:135], v[116:119], a[48:63]
    s_barrier
    ds_read_b64_tr_b16 v[132:133], v155 offset:4096
    ds_read_b64_tr_b16 v[134:135], v155 offset:5120
    s_waitcnt lgkmcnt(10)
    v_mfma_f32_32x32x16_bf16 a[0:15], v[136:139], v[120:123], a[0:15]
    ds_read_b64_tr_b16 v[136:137], v154 offset:12288
    ds_read_b64_tr_b16 v[138:139], v154 offset:13312
    s_waitcnt lgkmcnt(10)
    v_mfma_f32_32x32x16_bf16 a[16:31], v[140:143], v[120:123], a[16:31]
    ds_read_b64_tr_b16 v[140:141], v155 offset:12288
    ds_read_b64_tr_b16 v[142:143], v155 offset:13312
    s_waitcnt lgkmcnt(10)
    v_mfma_f32_32x32x16_bf16 a[32:47], v[144:147], v[120:123], a[32:47]
    s_waitcnt lgkmcnt(8)
    v_mfma_f32_32x32x16_bf16 a[48:63], v[148:151], v[120:123], a[48:63]
    s_waitcnt lgkmcnt(6)
    v_mfma_f32_32x32x16_bf16 a[0:15], v[128:131], v[124:127], a[0:15]
    s_waitcnt lgkmcnt(4)
    v_mfma_f32_32x32x16_bf16 a[16:31], v[132:135], v[124:127], a[16:31]
    s_waitcnt lgkmcnt(2)
    v_mfma_f32_32x32x16_bf16 a[32:47], v[136:139], v[124:127], a[32:47]
    s_waitcnt lgkmcnt(0)
    v_mfma_f32_32x32x16_bf16 a[48:63], v[140:143], v[124:127], a[48:63]
    s_lshr_b32 s52, s2, 3
    s_and_b32 s53, s2, 7
    s_mov_b32 s56, s16
    s_and_b32 s57, s17, 0xffff
    s_mov_b32 s58, 1605632
    s_mov_b32 s59, 0x00020000
    s_mul_i32 s54, s52, 57344
    v_lshlrev_b32 v9, 7, v0
    s_add_u32 s55, s54, 0
    buffer_load_dword v15, v9, s[56:59], s55 offen
    s_nop 15
    s_barrier
    v_mul_u32_u24 v165, 4608, v2
    v_and_b32 v11, 31, v1
    v_mul_u32_u24 v11, 144, v11
    v_add_u32 v165, v165, v11
    v_lshl_add_u32 v165, v7, 3, v165
    v_accvgpr_read_b32 v166, a0
    v_accvgpr_read_b32 v167, a1
    v_accvgpr_read_b32 v168, a2
    v_accvgpr_read_b32 v169, a3
    v_accvgpr_read_b32 v174, a32
    v_accvgpr_read_b32 v175, a33
    v_accvgpr_read_b32 v176, a34
    v_accvgpr_read_b32 v177, a35
    v_mul_f32 v170, 0xbfb8aa3b, v166
    v_mul_f32 v171, 0xbfb8aa3b, v167
    v_mul_f32 v172, 0xbfb8aa3b, v168
    v_mul_f32 v173, 0xbfb8aa3b, v169
    v_exp_f32 v170, v170
    v_exp_f32 v171, v171
    v_exp_f32 v172, v172
    v_exp_f32 v173, v173
    v_mul_f32 v166, v166, v174
    v_mul_f32 v167, v167, v175
    v_mul_f32 v168, v168, v176
    v_mul_f32 v169, v169, v177
    v_add_f32 v170, 1.0, v170
    v_add_f32 v171, 1.0, v171
    v_add_f32 v172, 1.0, v172
    v_add_f32 v173, 1.0, v173
    v_rcp_f32 v170, v170
    v_rcp_f32 v171, v171
    v_rcp_f32 v172, v172
    v_rcp_f32 v173, v173
    s_nop 0
    v_mul_f32 v166, v166, v170
    v_mul_f32 v167, v167, v171
    v_mul_f32 v168, v168, v172
    v_mul_f32 v169, v169, v173
    v_cvt_pk_bf16_f32 v170, v166, v167
    v_cvt_pk_bf16_f32 v171, v168, v169
    ds_write_b64 v165, v[170:171] offset:0
    v_accvgpr_read_b32 v178, a4
    v_accvgpr_read_b32 v179, a5
    v_accvgpr_read_b32 v180, a6
    v_accvgpr_read_b32 v181, a7
    v_accvgpr_read_b32 v186, a36
    v_accvgpr_read_b32 v187, a37
    v_accvgpr_read_b32 v188, a38
    v_accvgpr_read_b32 v189, a39
    v_mul_f32 v182, 0xbfb8aa3b, v178
    v_mul_f32 v183, 0xbfb8aa3b, v179
    v_mul_f32 v184, 0xbfb8aa3b, v180
    v_mul_f32 v185, 0xbfb8aa3b, v181
    v_exp_f32 v182, v182
    v_exp_f32 v183, v183
    v_exp_f32 v184, v184
    v_exp_f32 v185, v185
    v_mul_f32 v178, v178, v186
    v_mul_f32 v179, v179, v187
    v_mul_f32 v180, v180, v188
    v_mul_f32 v181, v181, v189
    v_add_f32 v182, 1.0, v182
    v_add_f32 v183, 1.0, v183
    v_add_f32 v184, 1.0, v184
    v_add_f32 v185, 1.0, v185
    v_rcp_f32 v182, v182
    v_rcp_f32 v183, v183
    v_rcp_f32 v184, v184
    v_rcp_f32 v185, v185
    s_nop 0
    v_mul_f32 v178, v178, v182
    v_mul_f32 v179, v179, v183
    v_mul_f32 v180, v180, v184
    v_mul_f32 v181, v181, v185
    v_cvt_pk_bf16_f32 v182, v178, v179
    v_cvt_pk_bf16_f32 v183, v180, v181
    ds_write_b64 v165, v[182:183] offset:16
    v_accvgpr_read_b32 v166, a8
    v_accvgpr_read_b32 v167, a9
    v_accvgpr_read_b32 v168, a10
    v_accvgpr_read_b32 v169, a11
    v_accvgpr_read_b32 v174, a40
    v_accvgpr_read_b32 v175, a41
    v_accvgpr_read_b32 v176, a42
    v_accvgpr_read_b32 v177, a43
    v_mul_f32 v170, 0xbfb8aa3b, v166
    v_mul_f32 v171, 0xbfb8aa3b, v167
    v_mul_f32 v172, 0xbfb8aa3b, v168
    v_mul_f32 v173, 0xbfb8aa3b, v169
    v_exp_f32 v170, v170
    v_exp_f32 v171, v171
    v_exp_f32 v172, v172
    v_exp_f32 v173, v173
    v_mul_f32 v166, v166, v174
    v_mul_f32 v167, v167, v175
    v_mul_f32 v168, v168, v176
    v_mul_f32 v169, v169, v177
    v_add_f32 v170, 1.0, v170
    v_add_f32 v171, 1.0, v171
    v_add_f32 v172, 1.0, v172
    v_add_f32 v173, 1.0, v173
    v_rcp_f32 v170, v170
    v_rcp_f32 v171, v171
    v_rcp_f32 v172, v172
    v_rcp_f32 v173, v173
    s_nop 0
    v_mul_f32 v166, v166, v170
    v_mul_f32 v167, v167, v171
    v_mul_f32 v168, v168, v172
    v_mul_f32 v169, v169, v173
    v_cvt_pk_bf16_f32 v170, v166, v167
    v_cvt_pk_bf16_f32 v171, v168, v169
    ds_write_b64 v165, v[170:171] offset:32
    v_accvgpr_read_b32 v178, a12
    v_accvgpr_read_b32 v179, a13
    v_accvgpr_read_b32 v180, a14
    v_accvgpr_read_b32 v181, a15
    v_accvgpr_read_b32 v186, a44
    v_accvgpr_read_b32 v187, a45
    v_accvgpr_read_b32 v188, a46
    v_accvgpr_read_b32 v189, a47
    v_mul_f32 v182, 0xbfb8aa3b, v178
    v_mul_f32 v183, 0xbfb8aa3b, v179
    v_mul_f32 v184, 0xbfb8aa3b, v180
    v_mul_f32 v185, 0xbfb8aa3b, v181
    v_exp_f32 v182, v182
    v_exp_f32 v183, v183
    v_exp_f32 v184, v184
    v_exp_f32 v185, v185
    v_mul_f32 v178, v178, v186
    v_mul_f32 v179, v179, v187
    v_mul_f32 v180, v180, v188
    v_mul_f32 v181, v181, v189
    v_add_f32 v182, 1.0, v182
    v_add_f32 v183, 1.0, v183
    v_add_f32 v184, 1.0, v184
    v_add_f32 v185, 1.0, v185
    v_rcp_f32 v182, v182
    v_rcp_f32 v183, v183
    v_rcp_f32 v184, v184
    v_rcp_f32 v185, v185
    s_nop 0
    v_mul_f32 v178, v178, v182
    v_mul_f32 v179, v179, v183
    v_mul_f32 v180, v180, v184
    v_mul_f32 v181, v181, v185
    v_cvt_pk_bf16_f32 v182, v178, v179
    v_cvt_pk_bf16_f32 v183, v180, v181
    ds_write_b64 v165, v[182:183] offset:48
    v_accvgpr_read_b32 v166, a16
    v_accvgpr_read_b32 v167, a17
    v_accvgpr_read_b32 v168, a18
    v_accvgpr_read_b32 v169, a19
    v_accvgpr_read_b32 v174, a48
    v_accvgpr_read_b32 v175, a49
    v_accvgpr_read_b32 v176, a50
    v_accvgpr_read_b32 v177, a51
    v_mul_f32 v170, 0xbfb8aa3b, v166
    v_mul_f32 v171, 0xbfb8aa3b, v167
    v_mul_f32 v172, 0xbfb8aa3b, v168
    v_mul_f32 v173, 0xbfb8aa3b, v169
    v_exp_f32 v170, v170
    v_exp_f32 v171, v171
    v_exp_f32 v172, v172
    v_exp_f32 v173, v173
    v_mul_f32 v166, v166, v174
    v_mul_f32 v167, v167, v175
    v_mul_f32 v168, v168, v176
    v_mul_f32 v169, v169, v177
    v_add_f32 v170, 1.0, v170
    v_add_f32 v171, 1.0, v171
    v_add_f32 v172, 1.0, v172
    v_add_f32 v173, 1.0, v173
    v_rcp_f32 v170, v170
    v_rcp_f32 v171, v171
    v_rcp_f32 v172, v172
    v_rcp_f32 v173, v173
    s_nop 0
    v_mul_f32 v166, v166, v170
    v_mul_f32 v167, v167, v171
    v_mul_f32 v168, v168, v172
    v_mul_f32 v169, v169, v173
    v_cvt_pk_bf16_f32 v170, v166, v167
    v_cvt_pk_bf16_f32 v171, v168, v169
    ds_write_b64 v165, v[170:171] offset:64
    v_accvgpr_read_b32 v178, a20
    v_accvgpr_read_b32 v179, a21
    v_accvgpr_read_b32 v180, a22
    v_accvgpr_read_b32 v181, a23
    v_accvgpr_read_b32 v186, a52
    v_accvgpr_read_b32 v187, a53
    v_accvgpr_read_b32 v188, a54
    v_accvgpr_read_b32 v189, a55
    v_mul_f32 v182, 0xbfb8aa3b, v178
    v_mul_f32 v183, 0xbfb8aa3b, v179
    v_mul_f32 v184, 0xbfb8aa3b, v180
    v_mul_f32 v185, 0xbfb8aa3b, v181
    v_exp_f32 v182, v182
    v_exp_f32 v183, v183
    v_exp_f32 v184, v184
    v_exp_f32 v185, v185
    v_mul_f32 v178, v178, v186
    v_mul_f32 v179, v179, v187
    v_mul_f32 v180, v180, v188
    v_mul_f32 v181, v181, v189
    v_add_f32 v182, 1.0, v182
    v_add_f32 v183, 1.0, v183
    v_add_f32 v184, 1.0, v184
    v_add_f32 v185, 1.0, v185
    v_rcp_f32 v182, v182
    v_rcp_f32 v183, v183
    v_rcp_f32 v184, v184
    v_rcp_f32 v185, v185
    s_nop 0
    v_mul_f32 v178, v178, v182
    v_mul_f32 v179, v179, v183
    v_mul_f32 v180, v180, v184
    v_mul_f32 v181, v181, v185
    v_cvt_pk_bf16_f32 v182, v178, v179
    v_cvt_pk_bf16_f32 v183, v180, v181
    ds_write_b64 v165, v[182:183] offset:80
    v_accvgpr_read_b32 v166, a24
    v_accvgpr_read_b32 v167, a25
    v_accvgpr_read_b32 v168, a26
    v_accvgpr_read_b32 v169, a27
    v_accvgpr_read_b32 v174, a56
    v_accvgpr_read_b32 v175, a57
    v_accvgpr_read_b32 v176, a58
    v_accvgpr_read_b32 v177, a59
    v_mul_f32 v170, 0xbfb8aa3b, v166
    v_mul_f32 v171, 0xbfb8aa3b, v167
    v_mul_f32 v172, 0xbfb8aa3b, v168
    v_mul_f32 v173, 0xbfb8aa3b, v169
    v_exp_f32 v170, v170
    v_exp_f32 v171, v171
    v_exp_f32 v172, v172
    v_exp_f32 v173, v173
    v_mul_f32 v166, v166, v174
    v_mul_f32 v167, v167, v175
    v_mul_f32 v168, v168, v176
    v_mul_f32 v169, v169, v177
    v_add_f32 v170, 1.0, v170
    v_add_f32 v171, 1.0, v171
    v_add_f32 v172, 1.0, v172
    v_add_f32 v173, 1.0, v173
    v_rcp_f32 v170, v170
    v_rcp_f32 v171, v171
    v_rcp_f32 v172, v172
    v_rcp_f32 v173, v173
    s_nop 0
    v_mul_f32 v166, v166, v170
    v_mul_f32 v167, v167, v171
    v_mul_f32 v168, v168, v172
    v_mul_f32 v169, v169, v173
    v_cvt_pk_bf16_f32 v170, v166, v167
    v_cvt_pk_bf16_f32 v171, v168, v169
    ds_write_b64 v165, v[170:171] offset:96
    v_accvgpr_read_b32 v178, a28
    v_accvgpr_read_b32 v179, a29
    v_accvgpr_read_b32 v180, a30
    v_accvgpr_read_b32 v181, a31
    v_accvgpr_read_b32 v186, a60
    v_accvgpr_read_b32 v187, a61
    v_accvgpr_read_b32 v188, a62
    v_accvgpr_read_b32 v189, a63
    v_mul_f32 v182, 0xbfb8aa3b, v178
    v_mul_f32 v183, 0xbfb8aa3b, v179
    v_mul_f32 v184, 0xbfb8aa3b, v180
    v_mul_f32 v185, 0xbfb8aa3b, v181
    v_exp_f32 v182, v182
    v_exp_f32 v183, v183
    v_exp_f32 v184, v184
    v_exp_f32 v185, v185
    v_mul_f32 v178, v178, v186
    v_mul_f32 v179, v179, v187
    v_mul_f32 v180, v180, v188
    v_mul_f32 v181, v181, v189
    v_add_f32 v182, 1.0, v182
    v_add_f32 v183, 1.0, v183
    v_add_f32 v184, 1.0, v184
    v_add_f32 v185, 1.0, v185
    v_rcp_f32 v182, v182
    v_rcp_f32 v183, v183
    v_rcp_f32 v184, v184
    v_rcp_f32 v185, v185
    s_nop 0
    v_mul_f32 v178, v178, v182
    v_mul_f32 v179, v179, v183
    v_mul_f32 v180, v180, v184
    v_mul_f32 v181, v181, v185
    v_cvt_pk_bf16_f32 v182, v178, v179
    v_cvt_pk_bf16_f32 v183, v180, v181
    ds_write_b64 v165, v[182:183] offset:112
    v_lshrrev_b32 v11, 3, v1
    v_and_b32 v12, 7, v1
    v_mul_u32_u24 v13, 4608, v2
    v_mul_u32_u24 v14, 144, v11
    v_add_u32 v13, v13, v14
    v_lshl_add_u32 v13, v12, 4, v13
    v_lshl_add_u32 v14, v3, 5, v11
    v_add_u32 v14, s25, v14
    s_mov_b32 s26, 3584
    v_mul_lo_u32 v14, v14, s26
    v_lshl_add_u32 v14, v12, 4, v14
    v_lshl_add_u32 v14, v4, 7, v14
    v_add_u32 v14, s27, v14
    s_waitcnt lgkmcnt(0)
    ds_read_b128 v[16:19], v13 offset:0
    ds_read_b128 v[20:23], v13 offset:1152
    ds_read_b128 v[24:27], v13 offset:2304
    ds_read_b128 v[28:31], v13 offset:3456
    s_waitcnt lgkmcnt(3)
    s_mov_b32 s48, 0
    buffer_store_dwordx4 v[16:19], v14, s[40:43], s48 offen
    s_waitcnt lgkmcnt(2)
    s_mov_b32 s48, 28672
    buffer_store_dwordx4 v[20:23], v14, s[40:43], s48 offen
    s_waitcnt lgkmcnt(1)
    s_mov_b32 s48, 57344
    buffer_store_dwordx4 v[24:27], v14, s[40:43], s48 offen
    s_waitcnt lgkmcnt(0)
    s_mov_b32 s48, 86016
    buffer_store_dwordx4 v[28:31], v14, s[40:43], s48 offen
k3_gu_kernel_done:
    s_endpgm
.section .rodata,"a"
.p2align 6
.amdhsa_kernel k3_gu_kernel
  .amdhsa_next_free_vgpr 256
  .amdhsa_next_free_sgpr 102
  .amdhsa_accum_offset 192
  .amdhsa_group_segment_fixed_size 0
  .amdhsa_kernarg_size 80
  .amdhsa_user_sgpr_count 2
  .amdhsa_user_sgpr_kernarg_segment_ptr 1
  .amdhsa_system_sgpr_workgroup_id_x 1
.end_amdhsa_kernel
.text
.globl k4_down_kernel
.p2align 8
.type k4_down_kernel,@function
k4_down_kernel:
    s_cmp_ge_u32 s2, 224
    s_cbranch_scc1 k4_down_kernel_done
    s_load_dwordx4 s[4:7], s[0:1], 0
    s_load_dwordx4 s[8:11], s[0:1], 16
    s_load_dwordx4 s[12:15], s[0:1], 32
    s_load_dwordx4 s[16:19], s[0:1], 48
    s_load_dwordx2 s[20:21], s[0:1], 72
    s_and_b32 s22, s2, 7
    s_mul_i32 s22, s22, 28
    s_lshr_b32 s23, s2, 3
    s_add_u32 s3, s22, s23
    s_mov_b32 s22, 613566757
    s_mul_hi_u32 s23, s3, s22
    s_mul_i32 s24, s23, 7
    s_sub_u32 s24, s3, s24
    v_and_b32 v1, 63, v0
    v_lshrrev_b32 v2, 6, v0
    v_lshrrev_b32 v7, 5, v1
    v_readfirstlane_b32 s50, v2
    s_waitcnt lgkmcnt(0)
    s_lshl_b32 s51, s50, 10
    s_add_u32 s28, s20, 10485760
    s_addc_u32 s29, s21, 0
    s_and_b32 s29, s29, 0xffff
    s_mov_b32 s30, 7340032
    s_mov_b32 s31, 0x00020000
    s_mov_b32 s32, s16
    s_and_b32 s33, s17, 0xffff
    s_mov_b32 s34, 1605632
    s_mov_b32 s35, 0x00020000
    s_mov_b32 s40, s18
    s_and_b32 s41, s19, 0xffff
    s_mov_b32 s42, 1835008
    s_mov_b32 s43, 0x00020000
    s_add_u32 s44, s20, 8388608
    s_addc_u32 s45, s21, 0
    s_and_b32 s45, s45, 0xffff
    s_mov_b32 s46, 1835008
    s_mov_b32 s47, 0x00020000
    v_and_b32 v3, 3, v2
    v_lshrrev_b32 v4, 2, v2
    s_lshl_b32 s25, s23, 6
    s_mul_i32 s26, s25, 3584
    s_lshl_b32 s27, s24, 7
    v_lshrrev_b32 v12, 3, v1
    v_lshl_add_u32 v12, v2, 3, v12
    s_mov_b32 s48, 3584
    v_mul_lo_u32 v12, v12, s48
    v_and_b32 v13, 1, v2
    v_lshlrev_b32 v13, 2, v13
    v_lshrrev_b32 v14, 4, v1
    v_add_u32 v13, v13, v14
    v_and_b32 v14, 7, v1
    v_xor_b32 v13, v13, v14
    v_lshl_add_u32 v47, v13, 4, v12
    v_add_u32 v47, s26, v47
    v_lshrrev_b32 v12, 3, v1
    v_lshl_add_u32 v13, v2, 3, v12
    s_mov_b32 s48, 896
    v_mul_lo_u32 v13, v13, s48
    v_bfe_u32 v14, v1, 2, 1
    v_bfe_u32 v15, v1, 4, 1
    v_xor_b32 v14, v14, v15
    v_lshl_add_u32 v13, v14, 6, v13
    v_and_b32 v14, 3, v1
    v_lshl_add_u32 v46, v14, 4, v13
    v_add_u32 v46, s27, v46
    s_mov_b32 s48, 0
    s_add_u32 m0, s51, 0
    s_nop 0
    buffer_load_dwordx4 v46, s[32:35], s48 offen lds
    s_mov_b32 s48, 0
    s_add_u32 m0, s51, 8192
    s_nop 0
    buffer_load_dwordx4 v47, s[28:31], s48 offen lds
    s_mov_b32 s48, 57344
    s_add_u32 m0, s51, 16384
    s_nop 0
    buffer_load_dwordx4 v46, s[32:35], s48 offen lds
    s_mov_b32 s48, 128
    s_add_u32 m0, s51, 24576
    s_nop 0
    buffer_load_dwordx4 v47, s[28:31], s48 offen lds
    s_mov_b32 s48, 114688
    s_add_u32 m0, s51, 32768
    s_nop 0
    buffer_load_dwordx4 v46, s[32:35], s48 offen lds
    s_mov_b32 s48, 256
    s_add_u32 m0, s51, 40960
    s_nop 0
    buffer_load_dwordx4 v47, s[28:31], s48 offen lds
    s_mov_b32 s48, 172032
    s_add_u32 m0, s51, 49152
    s_nop 0
    buffer_load_dwordx4 v46, s[32:35], s48 offen lds
    s_mov_b32 s48, 384
    s_add_u32 m0, s51, 57344
    s_nop 0
    buffer_load_dwordx4 v47, s[28:31], s48 offen lds
    s_mov_b32 s48, 229376
    s_add_u32 m0, s51, 65536
    s_nop 0
    buffer_load_dwordx4 v46, s[32:35], s48 offen lds
    s_mov_b32 s48, 512
    s_add_u32 m0, s51, 73728
    s_nop 0
    buffer_load_dwordx4 v47, s[28:31], s48 offen lds
    s_mov_b32 s48, 286720
    s_add_u32 m0, s51, 81920
    s_nop 0
    buffer_load_dwordx4 v46, s[32:35], s48 offen lds
    s_mov_b32 s48, 640
    s_add_u32 m0, s51, 90112
    s_nop 0
    buffer_load_dwordx4 v47, s[28:31], s48 offen lds
    s_mov_b32 s48, 344064
    s_add_u32 m0, s51, 98304
    s_nop 0
    buffer_load_dwordx4 v46, s[32:35], s48 offen lds
    s_mov_b32 s48, 768
    s_add_u32 m0, s51, 106496
    s_nop 0
    buffer_load_dwordx4 v47, s[28:31], s48 offen lds
    v_bfe_u32 v8, v1, 2, 2
    v_lshl_add_u32 v9, v7, 3, v8
    v_lshl_add_u32 v9, v3, 4, v9
    v_lshlrev_b32 v9, 7, v9
    v_bfe_u32 v10, v1, 4, 1
    v_lshl_add_u32 v9, v10, 5, v9
    v_and_b32 v10, 3, v1
    v_lshl_add_u32 v9, v10, 3, v9
    v_add_u32 v9, 0, v9
    v_bfe_u32 v8, v1, 3, 1
    v_xor_b32 v10, 0, v8
    v_lshl_add_u32 v40, v10, 6, v9
    v_add_u32 v42, 65536, v40
    v_xor_b32 v10, 1, v8
    v_lshl_add_u32 v41, v10, 6, v9
    v_add_u32 v43, 65536, v41
    v_and_b32 v5, 31, v1
    v_lshl_add_u32 v5, v4, 5, v5
    v_lshlrev_b32 v9, 7, v5
    v_bfe_u32 v8, v5, 1, 3
    v_lshl_add_u32 v10, v3, 1, v7
    v_xor_b32 v10, v10, v8
    v_lshl_add_u32 v44, v10, 4, v9
    v_add_u32 v44, 8192, v44
    v_add_u32 v45, 65536, v44
    v_accvgpr_write_b32 a0, 0
    v_accvgpr_write_b32 a1, 0
    v_accvgpr_write_b32 a2, 0
    v_accvgpr_write_b32 a3, 0
    v_accvgpr_write_b32 a4, 0
    v_accvgpr_write_b32 a5, 0
    v_accvgpr_write_b32 a6, 0
    v_accvgpr_write_b32 a7, 0
    v_accvgpr_write_b32 a8, 0
    v_accvgpr_write_b32 a9, 0
    v_accvgpr_write_b32 a10, 0
    v_accvgpr_write_b32 a11, 0
    v_accvgpr_write_b32 a12, 0
    v_accvgpr_write_b32 a13, 0
    v_accvgpr_write_b32 a14, 0
    v_accvgpr_write_b32 a15, 0
    v_accvgpr_write_b32 a16, 0
    v_accvgpr_write_b32 a17, 0
    v_accvgpr_write_b32 a18, 0
    v_accvgpr_write_b32 a19, 0
    v_accvgpr_write_b32 a20, 0
    v_accvgpr_write_b32 a21, 0
    v_accvgpr_write_b32 a22, 0
    v_accvgpr_write_b32 a23, 0
    v_accvgpr_write_b32 a24, 0
    v_accvgpr_write_b32 a25, 0
    v_accvgpr_write_b32 a26, 0
    v_accvgpr_write_b32 a27, 0
    v_accvgpr_write_b32 a28, 0
    v_accvgpr_write_b32 a29, 0
    v_accvgpr_write_b32 a30, 0
    v_accvgpr_write_b32 a31, 0
    s_waitcnt vmcnt(8)
    s_barrier
    ds_read_b128 v[16:19], v44 offset:0
    ds_read_b64_tr_b16 v[20:21], v40 offset:0
    ds_read_b64_tr_b16 v[22:23], v40 offset:512
    ds_read_b64_tr_b16 v[24:25], v41 offset:0
    ds_read_b64_tr_b16 v[26:27], v41 offset:512
    s_mov_b32 s48, 401408
    s_add_u32 m0, s51, 114688
    s_nop 0
    buffer_load_dwordx4 v46, s[32:35], s48 offen lds
    s_mov_b32 s48, 896
    s_add_u32 m0, s51, 122880
    s_nop 0
    buffer_load_dwordx4 v47, s[28:31], s48 offen lds
    ds_read_b128 v[28:31], v44 offset:16384
    ds_read_b64_tr_b16 v[32:33], v40 offset:16384
    ds_read_b64_tr_b16 v[34:35], v40 offset:16896
    ds_read_b64_tr_b16 v[36:37], v41 offset:16384
    ds_read_b64_tr_b16 v[38:39], v41 offset:16896
    s_waitcnt lgkmcnt(7)
    v_mfma_f32_32x32x16_bf16 a[0:15], v[20:23], v[16:19], a[0:15]
    s_waitcnt lgkmcnt(5)
    v_mfma_f32_32x32x16_bf16 a[16:31], v[24:27], v[16:19], a[16:31]
    ds_read_b128 v[16:19], v44 offset:32768
    ds_read_b64_tr_b16 v[20:21], v40 offset:32768
    ds_read_b64_tr_b16 v[22:23], v40 offset:33280
    ds_read_b64_tr_b16 v[24:25], v41 offset:32768
    ds_read_b64_tr_b16 v[26:27], v41 offset:33280
    s_waitcnt lgkmcnt(7)
    v_mfma_f32_32x32x16_bf16 a[0:15], v[32:35], v[28:31], a[0:15]
    s_waitcnt lgkmcnt(5)
    v_mfma_f32_32x32x16_bf16 a[16:31], v[36:39], v[28:31], a[16:31]
    s_waitcnt vmcnt(6)
    s_barrier
    s_mov_b32 s48, 458752
    s_add_u32 m0, s51, 0
    s_nop 0
    buffer_load_dwordx4 v46, s[32:35], s48 offen lds
    s_mov_b32 s48, 1024
    s_add_u32 m0, s51, 8192
    s_nop 0
    buffer_load_dwordx4 v47, s[28:31], s48 offen lds
    s_mov_b32 s48, 516096
    s_add_u32 m0, s51, 16384
    s_nop 0
    buffer_load_dwordx4 v46, s[32:35], s48 offen lds
    s_mov_b32 s48, 1152
    s_add_u32 m0, s51, 24576
    s_nop 0
    buffer_load_dwordx4 v47, s[28:31], s48 offen lds
    ds_read_b128 v[28:31], v44 offset:49152
    ds_read_b64_tr_b16 v[32:33], v40 offset:49152
    ds_read_b64_tr_b16 v[34:35], v40 offset:49664
    ds_read_b64_tr_b16 v[36:37], v41 offset:49152
    ds_read_b64_tr_b16 v[38:39], v41 offset:49664
    s_waitcnt lgkmcnt(7)
    v_mfma_f32_32x32x16_bf16 a[0:15], v[20:23], v[16:19], a[0:15]
    s_waitcnt lgkmcnt(5)
    v_mfma_f32_32x32x16_bf16 a[16:31], v[24:27], v[16:19], a[16:31]
    ds_read_b128 v[16:19], v45 offset:0
    ds_read_b64_tr_b16 v[20:21], v42 offset:0
    ds_read_b64_tr_b16 v[22:23], v42 offset:512
    ds_read_b64_tr_b16 v[24:25], v43 offset:0
    ds_read_b64_tr_b16 v[26:27], v43 offset:512
    s_waitcnt lgkmcnt(7)
    v_mfma_f32_32x32x16_bf16 a[0:15], v[32:35], v[28:31], a[0:15]
    s_waitcnt lgkmcnt(5)
    v_mfma_f32_32x32x16_bf16 a[16:31], v[36:39], v[28:31], a[16:31]
    s_waitcnt vmcnt(6)
    s_barrier
    s_mov_b32 s48, 573440
    s_add_u32 m0, s51, 32768
    s_nop 0
    buffer_load_dwordx4 v46, s[32:35], s48 offen lds
    s_mov_b32 s48, 1280
    s_add_u32 m0, s51, 40960
    s_nop 0
    buffer_load_dwordx4 v47, s[28:31], s48 offen lds
    s_mov_b32 s48, 630784
    s_add_u32 m0, s51, 49152
    s_nop 0
    buffer_load_dwordx4 v46, s[32:35], s48 offen lds
    s_mov_b32 s48, 1408
    s_add_u32 m0, s51, 57344
    s_nop 0
    buffer_load_dwordx4 v47, s[28:31], s48 offen lds
    ds_read_b128 v[28:31], v45 offset:16384
    ds_read_b64_tr_b16 v[32:33], v42 offset:16384
    ds_read_b64_tr_b16 v[34:35], v42 offset:16896
    ds_read_b64_tr_b16 v[36:37], v43 offset:16384
    ds_read_b64_tr_b16 v[38:39], v43 offset:16896
    s_waitcnt lgkmcnt(7)
    v_mfma_f32_32x32x16_bf16 a[0:15], v[20:23], v[16:19], a[0:15]
    s_waitcnt lgkmcnt(5)
    v_mfma_f32_32x32x16_bf16 a[16:31], v[24:27], v[16:19], a[16:31]
    ds_read_b128 v[16:19], v45 offset:32768
    ds_read_b64_tr_b16 v[20:21], v42 offset:32768
    ds_read_b64_tr_b16 v[22:23], v42 offset:33280
    ds_read_b64_tr_b16 v[24:25], v43 offset:32768
    ds_read_b64_tr_b16 v[26:27], v43 offset:33280
    s_waitcnt lgkmcnt(7)
    v_mfma_f32_32x32x16_bf16 a[0:15], v[32:35], v[28:31], a[0:15]
    s_waitcnt lgkmcnt(5)
    v_mfma_f32_32x32x16_bf16 a[16:31], v[36:39], v[28:31], a[16:31]
    s_waitcnt vmcnt(6)
    s_barrier
    s_mov_b32 s48, 688128
    s_add_u32 m0, s51, 65536
    s_nop 0
    buffer_load_dwordx4 v46, s[32:35], s48 offen lds
    s_mov_b32 s48, 1536
    s_add_u32 m0, s51, 73728
    s_nop 0
    buffer_load_dwordx4 v47, s[28:31], s48 offen lds
    s_mov_b32 s48, 745472
    s_add_u32 m0, s51, 81920
    s_nop 0
    buffer_load_dwordx4 v46, s[32:35], s48 offen lds
    s_mov_b32 s48, 1664
    s_add_u32 m0, s51, 90112
    s_nop 0
    buffer_load_dwordx4 v47, s[28:31], s48 offen lds
    ds_read_b128 v[28:31], v45 offset:49152
    ds_read_b64_tr_b16 v[32:33], v42 offset:49152
    ds_read_b64_tr_b16 v[34:35], v42 offset:49664
    ds_read_b64_tr_b16 v[36:37], v43 offset:49152
    ds_read_b64_tr_b16 v[38:39], v43 offset:49664
    s_waitcnt lgkmcnt(7)
    v_mfma_f32_32x32x16_bf16 a[0:15], v[20:23], v[16:19], a[0:15]
    s_waitcnt lgkmcnt(5)
    v_mfma_f32_32x32x16_bf16 a[16:31], v[24:27], v[16:19], a[16:31]
    ds_read_b128 v[16:19], v44 offset:0
    ds_read_b64_tr_b16 v[20:21], v40 offset:0
    ds_read_b64_tr_b16 v[22:23], v40 offset:512
    ds_read_b64_tr_b16 v[24:25], v41 offset:0
    ds_read_b64_tr_b16 v[26:27], v41 offset:512
    s_waitcnt lgkmcnt(7)
    v_mfma_f32_32x32x16_bf16 a[0:15], v[32:35], v[28:31], a[0:15]
    s_waitcnt lgkmcnt(5)
    v_mfma_f32_32x32x16_bf16 a[16:31], v[36:39], v[28:31], a[16:31]
    s_waitcnt vmcnt(6)
    s_barrier
    s_mov_b32 s48, 802816
    s_add_u32 m0, s51, 98304
    s_nop 0
    buffer_load_dwordx4 v46, s[32:35], s48 offen lds
    s_mov_b32 s48, 1792
    s_add_u32 m0, s51, 106496
    s_nop 0
    buffer_load_dwordx4 v47, s[28:31], s48 offen lds
    s_mov_b32 s48, 860160
    s_add_u32 m0, s51, 114688
    s_nop 0
    buffer_load_dwordx4 v46, s[32:35], s48 offen lds
    s_mov_b32 s48, 1920
    s_add_u32 m0, s51, 122880
    s_nop 0
    buffer_load_dwordx4 v47, s[28:31], s48 offen lds
    ds_read_b128 v[28:31], v44 offset:16384
    ds_read_b64_tr_b16 v[32:33], v40 offset:16384
    ds_read_b64_tr_b16 v[34:35], v40 offset:16896
    ds_read_b64_tr_b16 v[36:37], v41 offset:16384
    ds_read_b64_tr_b16 v[38:39], v41 offset:16896
    s_waitcnt lgkmcnt(7)
    v_mfma_f32_32x32x16_bf16 a[0:15], v[20:23], v[16:19], a[0:15]
    s_waitcnt lgkmcnt(5)
    v_mfma_f32_32x32x16_bf16 a[16:31], v[24:27], v[16:19], a[16:31]
    ds_read_b128 v[16:19], v44 offset:32768
    ds_read_b64_tr_b16 v[20:21], v40 offset:32768
    ds_read_b64_tr_b16 v[22:23], v40 offset:33280
    ds_read_b64_tr_b16 v[24:25], v41 offset:32768
    ds_read_b64_tr_b16 v[26:27], v41 offset:33280
    s_waitcnt lgkmcnt(7)
    v_mfma_f32_32x32x16_bf16 a[0:15], v[32:35], v[28:31], a[0:15]
    s_waitcnt lgkmcnt(5)
    v_mfma_f32_32x32x16_bf16 a[16:31], v[36:39], v[28:31], a[16:31]
    s_waitcnt vmcnt(6)
    s_barrier
    s_mov_b32 s48, 917504
    s_add_u32 m0, s51, 0
    s_nop 0
    buffer_load_dwordx4 v46, s[32:35], s48 offen lds
    s_mov_b32 s48, 2048
    s_add_u32 m0, s51, 8192
    s_nop 0
    buffer_load_dwordx4 v47, s[28:31], s48 offen lds
    s_mov_b32 s48, 974848
    s_add_u32 m0, s51, 16384
    s_nop 0
    buffer_load_dwordx4 v46, s[32:35], s48 offen lds
    s_mov_b32 s48, 2176
    s_add_u32 m0, s51, 24576
    s_nop 0
    buffer_load_dwordx4 v47, s[28:31], s48 offen lds
    ds_read_b128 v[28:31], v44 offset:49152
    ds_read_b64_tr_b16 v[32:33], v40 offset:49152
    ds_read_b64_tr_b16 v[34:35], v40 offset:49664
    ds_read_b64_tr_b16 v[36:37], v41 offset:49152
    ds_read_b64_tr_b16 v[38:39], v41 offset:49664
    s_waitcnt lgkmcnt(7)
    v_mfma_f32_32x32x16_bf16 a[0:15], v[20:23], v[16:19], a[0:15]
    s_waitcnt lgkmcnt(5)
    v_mfma_f32_32x32x16_bf16 a[16:31], v[24:27], v[16:19], a[16:31]
    ds_read_b128 v[16:19], v45 offset:0
    ds_read_b64_tr_b16 v[20:21], v42 offset:0
    ds_read_b64_tr_b16 v[22:23], v42 offset:512
    ds_read_b64_tr_b16 v[24:25], v43 offset:0
    ds_read_b64_tr_b16 v[26:27], v43 offset:512
    s_waitcnt lgkmcnt(7)
    v_mfma_f32_32x32x16_bf16 a[0:15], v[32:35], v[28:31], a[0:15]
    s_waitcnt lgkmcnt(5)
    v_mfma_f32_32x32x16_bf16 a[16:31], v[36:39], v[28:31], a[16:31]
    s_waitcnt vmcnt(6)
    s_barrier
    s_mov_b32 s48, 1032192
    s_add_u32 m0, s51, 32768
    s_nop 0
    buffer_load_dwordx4 v46, s[32:35], s48 offen lds
    s_mov_b32 s48, 2304
    s_add_u32 m0, s51, 40960
    s_nop 0
    buffer_load_dwordx4 v47, s[28:31], s48 offen lds
    s_mov_b32 s48, 1089536
    s_add_u32 m0, s51, 49152
    s_nop 0
    buffer_load_dwordx4 v46, s[32:35], s48 offen lds
    s_mov_b32 s48, 2432
    s_add_u32 m0, s51, 57344
    s_nop 0
    buffer_load_dwordx4 v47, s[28:31], s48 offen lds
    ds_read_b128 v[28:31], v45 offset:16384
    ds_read_b64_tr_b16 v[32:33], v42 offset:16384
    ds_read_b64_tr_b16 v[34:35], v42 offset:16896
    ds_read_b64_tr_b16 v[36:37], v43 offset:16384
    ds_read_b64_tr_b16 v[38:39], v43 offset:16896
    s_waitcnt lgkmcnt(7)
    v_mfma_f32_32x32x16_bf16 a[0:15], v[20:23], v[16:19], a[0:15]
    s_waitcnt lgkmcnt(5)
    v_mfma_f32_32x32x16_bf16 a[16:31], v[24:27], v[16:19], a[16:31]
    ds_read_b128 v[16:19], v45 offset:32768
    ds_read_b64_tr_b16 v[20:21], v42 offset:32768
    ds_read_b64_tr_b16 v[22:23], v42 offset:33280
    ds_read_b64_tr_b16 v[24:25], v43 offset:32768
    ds_read_b64_tr_b16 v[26:27], v43 offset:33280
    s_waitcnt lgkmcnt(7)
    v_mfma_f32_32x32x16_bf16 a[0:15], v[32:35], v[28:31], a[0:15]
    s_waitcnt lgkmcnt(5)
    v_mfma_f32_32x32x16_bf16 a[16:31], v[36:39], v[28:31], a[16:31]
    s_waitcnt vmcnt(6)
    s_barrier
    s_mov_b32 s48, 1146880
    s_add_u32 m0, s51, 65536
    s_nop 0
    buffer_load_dwordx4 v46, s[32:35], s48 offen lds
    s_mov_b32 s48, 2560
    s_add_u32 m0, s51, 73728
    s_nop 0
    buffer_load_dwordx4 v47, s[28:31], s48 offen lds
    s_mov_b32 s48, 1204224
    s_add_u32 m0, s51, 81920
    s_nop 0
    buffer_load_dwordx4 v46, s[32:35], s48 offen lds
    s_mov_b32 s48, 2688
    s_add_u32 m0, s51, 90112
    s_nop 0
    buffer_load_dwordx4 v47, s[28:31], s48 offen lds
    ds_read_b128 v[28:31], v45 offset:49152
    ds_read_b64_tr_b16 v[32:33], v42 offset:49152
    ds_read_b64_tr_b16 v[34:35], v42 offset:49664
    ds_read_b64_tr_b16 v[36:37], v43 offset:49152
    ds_read_b64_tr_b16 v[38:39], v43 offset:49664
    s_waitcnt lgkmcnt(7)
    v_mfma_f32_32x32x16_bf16 a[0:15], v[20:23], v[16:19], a[0:15]
    s_waitcnt lgkmcnt(5)
    v_mfma_f32_32x32x16_bf16 a[16:31], v[24:27], v[16:19], a[16:31]
    ds_read_b128 v[16:19], v44 offset:0
    ds_read_b64_tr_b16 v[20:21], v40 offset:0
    ds_read_b64_tr_b16 v[22:23], v40 offset:512
    ds_read_b64_tr_b16 v[24:25], v41 offset:0
    ds_read_b64_tr_b16 v[26:27], v41 offset:512
    s_waitcnt lgkmcnt(7)
    v_mfma_f32_32x32x16_bf16 a[0:15], v[32:35], v[28:31], a[0:15]
    s_waitcnt lgkmcnt(5)
    v_mfma_f32_32x32x16_bf16 a[16:31], v[36:39], v[28:31], a[16:31]
    s_waitcnt vmcnt(6)
    s_barrier
    s_mov_b32 s48, 1261568
    s_add_u32 m0, s51, 98304
    s_nop 0
    buffer_load_dwordx4 v46, s[32:35], s48 offen lds
    s_mov_b32 s48, 2816
    s_add_u32 m0, s51, 106496
    s_nop 0
    buffer_load_dwordx4 v47, s[28:31], s48 offen lds
    s_mov_b32 s48, 1318912
    s_add_u32 m0, s51, 114688
    s_nop 0
    buffer_load_dwordx4 v46, s[32:35], s48 offen lds
    s_mov_b32 s48, 2944
    s_add_u32 m0, s51, 122880
    s_nop 0
    buffer_load_dwordx4 v47, s[28:31], s48 offen lds
    ds_read_b128 v[28:31], v44 offset:16384
    ds_read_b64_tr_b16 v[32:33], v40 offset:16384
    ds_read_b64_tr_b16 v[34:35], v40 offset:16896
    ds_read_b64_tr_b16 v[36:37], v41 offset:16384
    ds_read_b64_tr_b16 v[38:39], v41 offset:16896
    s_waitcnt lgkmcnt(7)
    v_mfma_f32_32x32x16_bf16 a[0:15], v[20:23], v[16:19], a[0:15]
    s_waitcnt lgkmcnt(5)
    v_mfma_f32_32x32x16_bf16 a[16:31], v[24:27], v[16:19], a[16:31]
    ds_read_b128 v[16:19], v44 offset:32768
    ds_read_b64_tr_b16 v[20:21], v40 offset:32768
    ds_read_b64_tr_b16 v[22:23], v40 offset:33280
    ds_read_b64_tr_b16 v[24:25], v41 offset:32768
    ds_read_b64_tr_b16 v[26:27], v41 offset:33280
    s_waitcnt lgkmcnt(7)
    v_mfma_f32_32x32x16_bf16 a[0:15], v[32:35], v[28:31], a[0:15]
    s_waitcnt lgkmcnt(5)
    v_mfma_f32_32x32x16_bf16 a[16:31], v[36:39], v[28:31], a[16:31]
    s_waitcnt vmcnt(6)
    s_barrier
    s_mov_b32 s48, 1376256
    s_add_u32 m0, s51, 0
    s_nop 0
    buffer_load_dwordx4 v46, s[32:35], s48 offen lds
    s_mov_b32 s48, 3072
    s_add_u32 m0, s51, 8192
    s_nop 0
    buffer_load_dwordx4 v47, s[28:31], s48 offen lds
    s_mov_b32 s48, 1433600
    s_add_u32 m0, s51, 16384
    s_nop 0
    buffer_load_dwordx4 v46, s[32:35], s48 offen lds
    s_mov_b32 s48, 3200
    s_add_u32 m0, s51, 24576
    s_nop 0
    buffer_load_dwordx4 v47, s[28:31], s48 offen lds
    ds_read_b128 v[28:31], v44 offset:49152
    ds_read_b64_tr_b16 v[32:33], v40 offset:49152
    ds_read_b64_tr_b16 v[34:35], v40 offset:49664
    ds_read_b64_tr_b16 v[36:37], v41 offset:49152
    ds_read_b64_tr_b16 v[38:39], v41 offset:49664
    s_waitcnt lgkmcnt(7)
    v_mfma_f32_32x32x16_bf16 a[0:15], v[20:23], v[16:19], a[0:15]
    s_waitcnt lgkmcnt(5)
    v_mfma_f32_32x32x16_bf16 a[16:31], v[24:27], v[16:19], a[16:31]
    ds_read_b128 v[16:19], v45 offset:0
    ds_read_b64_tr_b16 v[20:21], v42 offset:0
    ds_read_b64_tr_b16 v[22:23], v42 offset:512
    ds_read_b64_tr_b16 v[24:25], v43 offset:0
    ds_read_b64_tr_b16 v[26:27], v43 offset:512
    s_waitcnt lgkmcnt(7)
    v_mfma_f32_32x32x16_bf16 a[0:15], v[32:35], v[28:31], a[0:15]
    s_waitcnt lgkmcnt(5)
    v_mfma_f32_32x32x16_bf16 a[16:31], v[36:39], v[28:31], a[16:31]
    s_waitcnt vmcnt(6)
    s_barrier
    s_mov_b32 s48, 1490944
    s_add_u32 m0, s51, 32768
    s_nop 0
    buffer_load_dwordx4 v46, s[32:35], s48 offen lds
    s_mov_b32 s48, 3328
    s_add_u32 m0, s51, 40960
    s_nop 0
    buffer_load_dwordx4 v47, s[28:31], s48 offen lds
    s_mov_b32 s48, 1548288
    s_add_u32 m0, s51, 49152
    s_nop 0
    buffer_load_dwordx4 v46, s[32:35], s48 offen lds
    s_mov_b32 s48, 3456
    s_add_u32 m0, s51, 57344
    s_nop 0
    buffer_load_dwordx4 v47, s[28:31], s48 offen lds
    ds_read_b128 v[28:31], v45 offset:16384
    ds_read_b64_tr_b16 v[32:33], v42 offset:16384
    ds_read_b64_tr_b16 v[34:35], v42 offset:16896
    ds_read_b64_tr_b16 v[36:37], v43 offset:16384
    ds_read_b64_tr_b16 v[38:39], v43 offset:16896
    s_waitcnt lgkmcnt(7)
    v_mfma_f32_32x32x16_bf16 a[0:15], v[20:23], v[16:19], a[0:15]
    s_waitcnt lgkmcnt(5)
    v_mfma_f32_32x32x16_bf16 a[16:31], v[24:27], v[16:19], a[16:31]
    ds_read_b128 v[16:19], v45 offset:32768
    ds_read_b64_tr_b16 v[20:21], v42 offset:32768
    ds_read_b64_tr_b16 v[22:23], v42 offset:33280
    ds_read_b64_tr_b16 v[24:25], v43 offset:32768
    ds_read_b64_tr_b16 v[26:27], v43 offset:33280
    s_waitcnt lgkmcnt(7)
    v_mfma_f32_32x32x16_bf16 a[0:15], v[32:35], v[28:31], a[0:15]
    s_waitcnt lgkmcnt(5)
    v_mfma_f32_32x32x16_bf16 a[16:31], v[36:39], v[28:31], a[16:31]
    s_waitcnt vmcnt(6)
    s_barrier
    ds_read_b128 v[28:31], v45 offset:49152
    ds_read_b64_tr_b16 v[32:33], v42 offset:49152
    ds_read_b64_tr_b16 v[34:35], v42 offset:49664
    ds_read_b64_tr_b16 v[36:37], v43 offset:49152
    ds_read_b64_tr_b16 v[38:39], v43 offset:49664
    s_waitcnt lgkmcnt(7)
    v_mfma_f32_32x32x16_bf16 a[0:15], v[20:23], v[16:19], a[0:15]
    s_waitcnt lgkmcnt(5)
    v_mfma_f32_32x32x16_bf16 a[16:31], v[24:27], v[16:19], a[16:31]
    ds_read_b128 v[16:19], v44 offset:0
    ds_read_b64_tr_b16 v[20:21], v40 offset:0
    ds_read_b64_tr_b16 v[22:23], v40 offset:512
    ds_read_b64_tr_b16 v[24:25], v41 offset:0
    ds_read_b64_tr_b16 v[26:27], v41 offset:512
    s_waitcnt lgkmcnt(7)
    v_mfma_f32_32x32x16_bf16 a[0:15], v[32:35], v[28:31], a[0:15]
    s_waitcnt lgkmcnt(5)
    v_mfma_f32_32x32x16_bf16 a[16:31], v[36:39], v[28:31], a[16:31]
    s_waitcnt vmcnt(2)
    s_barrier
    ds_read_b128 v[28:31], v44 offset:16384
    ds_read_b64_tr_b16 v[32:33], v40 offset:16384
    ds_read_b64_tr_b16 v[34:35], v40 offset:16896
    ds_read_b64_tr_b16 v[36:37], v41 offset:16384
    ds_read_b64_tr_b16 v[38:39], v41 offset:16896
    s_waitcnt lgkmcnt(7)
    v_mfma_f32_32x32x16_bf16 a[0:15], v[20:23], v[16:19], a[0:15]
    s_waitcnt lgkmcnt(5)
    v_mfma_f32_32x32x16_bf16 a[16:31], v[24:27], v[16:19], a[16:31]
    ds_read_b128 v[16:19], v44 offset:32768
    ds_read_b64_tr_b16 v[20:21], v40 offset:32768
    ds_read_b64_tr_b16 v[22:23], v40 offset:33280
    ds_read_b64_tr_b16 v[24:25], v41 offset:32768
    ds_read_b64_tr_b16 v[26:27], v41 offset:33280
    s_waitcnt lgkmcnt(7)
    v_mfma_f32_32x32x16_bf16 a[0:15], v[32:35], v[28:31], a[0:15]
    s_waitcnt lgkmcnt(5)
    v_mfma_f32_32x32x16_bf16 a[16:31], v[36:39], v[28:31], a[16:31]
    s_waitcnt vmcnt(0)
    s_barrier
    ds_read_b128 v[28:31], v44 offset:49152
    ds_read_b64_tr_b16 v[32:33], v40 offset:49152
    ds_read_b64_tr_b16 v[34:35], v40 offset:49664
    ds_read_b64_tr_b16 v[36:37], v41 offset:49152
    ds_read_b64_tr_b16 v[38:39], v41 offset:49664
    s_waitcnt lgkmcnt(7)
    v_mfma_f32_32x32x16_bf16 a[0:15], v[20:23], v[16:19], a[0:15]
    s_waitcnt lgkmcnt(5)
    v_mfma_f32_32x32x16_bf16 a[16:31], v[24:27], v[16:19], a[16:31]
    s_waitcnt lgkmcnt(2)
    v_mfma_f32_32x32x16_bf16 a[0:15], v[32:35], v[28:31], a[0:15]
    s_waitcnt lgkmcnt(0)
    v_mfma_f32_32x32x16_bf16 a[16:31], v[36:39], v[28:31], a[16:31]
    s_nop 15
    s_barrier
    v_mul_u32_u24 v10, 17408, v3
    v_mul_u32_u24 v11, 272, v5
    v_add_u32 v10, v10, v11
    v_lshl_add_u32 v10, v7, 4, v10
    v_accvgpr_read_b32 v100, a0
    v_accvgpr_read_b32 v101, a1
    v_accvgpr_read_b32 v102, a2
    v_accvgpr_read_b32 v103, a3
    ds_write_b128 v10, v[100:103] offset:0
    v_accvgpr_read_b32 v100, a4
    v_accvgpr_read_b32 v101, a5
    v_accvgpr_read_b32 v102, a6
    v_accvgpr_read_b32 v103, a7
    ds_write_b128 v10, v[100:103] offset:32
    v_accvgpr_read_b32 v100, a8
    v_accvgpr_read_b32 v101, a9
    v_accvgpr_read_b32 v102, a10
    v_accvgpr_read_b32 v103, a11
    ds_write_b128 v10, v[100:103] offset:64
    v_accvgpr_read_b32 v100, a12
    v_accvgpr_read_b32 v101, a13
    v_accvgpr_read_b32 v102, a14
    v_accvgpr_read_b32 v103, a15
    ds_write_b128 v10, v[100:103] offset:96
    v_accvgpr_read_b32 v100, a16
    v_accvgpr_read_b32 v101, a17
    v_accvgpr_read_b32 v102, a18
    v_accvgpr_read_b32 v103, a19
    ds_write_b128 v10, v[100:103] offset:128
    v_accvgpr_read_b32 v100, a20
    v_accvgpr_read_b32 v101, a21
    v_accvgpr_read_b32 v102, a22
    v_accvgpr_read_b32 v103, a23
    ds_write_b128 v10, v[100:103] offset:160
    v_accvgpr_read_b32 v100, a24
    v_accvgpr_read_b32 v101, a25
    v_accvgpr_read_b32 v102, a26
    v_accvgpr_read_b32 v103, a27
    ds_write_b128 v10, v[100:103] offset:192
    v_accvgpr_read_b32 v100, a28
    v_accvgpr_read_b32 v101, a29
    v_accvgpr_read_b32 v102, a30
    v_accvgpr_read_b32 v103, a31
    ds_write_b128 v10, v[100:103] offset:224
    v_lshrrev_b32 v11, 3, v1
    v_lshl_add_u32 v11, v2, 3, v11
    v_and_b32 v12, 7, v1
    v_mul_u32_u24 v13, 272, v11
    v_lshl_add_u32 v13, v12, 5, v13
    v_add_u32 v14, s25, v11
    s_mov_b32 s26, 896
    v_mul_lo_u32 v14, v14, s26
    v_lshl_add_u32 v14, v12, 4, v14
    v_add_u32 v14, s27, v14
    buffer_load_dwordx4 v[80:83], v14, s[44:47], 0 offen
    s_waitcnt lgkmcnt(0)
    s_barrier
    ds_read_b128 v[48:51], v13 offset:0
    ds_read_b128 v[52:55], v13 offset:16
    ds_read_b128 v[56:59], v13 offset:17408
    ds_read_b128 v[60:63], v13 offset:17424
    ds_read_b128 v[64:67], v13 offset:34816
    ds_read_b128 v[68:71], v13 offset:34832
    ds_read_b128 v[72:75], v13 offset:52224
    ds_read_b128 v[76:79], v13 offset:52240
    s_waitcnt vmcnt(0) lgkmcnt(0)
    v_add_f32 v48, v48, v56
    v_add_f32 v64, v64, v72
    v_add_f32 v48, v48, v64
    v_add_f32 v49, v49, v57
    v_add_f32 v65, v65, v73
    v_add_f32 v49, v49, v65
    v_add_f32 v50, v50, v58
    v_add_f32 v66, v66, v74
    v_add_f32 v50, v50, v66
    v_add_f32 v51, v51, v59
    v_add_f32 v67, v67, v75
    v_add_f32 v51, v51, v67
    v_add_f32 v52, v52, v60
    v_add_f32 v68, v68, v76
    v_add_f32 v52, v52, v68
    v_add_f32 v53, v53, v61
    v_add_f32 v69, v69, v77
    v_add_f32 v53, v53, v69
    v_add_f32 v54, v54, v62
    v_add_f32 v70, v70, v78
    v_add_f32 v54, v54, v70
    v_add_f32 v55, v55, v63
    v_add_f32 v71, v71, v79
    v_add_f32 v55, v55, v71
    v_lshlrev_b32 v100, 16, v80
    v_and_b32 v101, 0xffff0000, v80
    v_add_f32 v100, v100, v48
    v_add_f32 v101, v101, v49
    v_cvt_pk_bf16_f32 v80, v100, v101
    v_lshlrev_b32 v100, 16, v81
    v_and_b32 v101, 0xffff0000, v81
    v_add_f32 v100, v100, v50
    v_add_f32 v101, v101, v51
    v_cvt_pk_bf16_f32 v81, v100, v101
    v_lshlrev_b32 v100, 16, v82
    v_and_b32 v101, 0xffff0000, v82
    v_add_f32 v100, v100, v52
    v_add_f32 v101, v101, v53
    v_cvt_pk_bf16_f32 v82, v100, v101
    v_lshlrev_b32 v100, 16, v83
    v_and_b32 v101, 0xffff0000, v83
    v_add_f32 v100, v100, v54
    v_add_f32 v101, v101, v55
    v_cvt_pk_bf16_f32 v83, v100, v101
    buffer_store_dwordx4 v[80:83], v14, s[40:43], 0 offen
k4_down_kernel_done:
    s_endpgm
.section .rodata,"a"
.p2align 6
.amdhsa_kernel k4_down_kernel
  .amdhsa_next_free_vgpr 160
  .amdhsa_next_free_sgpr 102
  .amdhsa_accum_offset 128
  .amdhsa_group_segment_fixed_size 0
  .amdhsa_kernarg_size 80
  .amdhsa_user_sgpr_count 2
  .amdhsa_user_sgpr_kernarg_segment_ptr 1
  .amdhsa_system_sgpr_workgroup_id_x 1
.end_amdhsa_kernel
.text
```
